```python
import torch

def _softmax(x, axis=-1):
    return torch.softmax(x, dim=axis)

def _gelu(x):
    return torch.nn.functional.gelu(x, approximate='tanh')

def _silu(x):
    return torch.nn.functional.silu(x)

def _sigmoid(x):
    return torch.sigmoid(x)

def _layernorm(x, axis=-1, eps=1e-05):
    m = x.mean(dim=axis, keepdim=True)
    v = x.var(dim=axis, keepdim=True, unbiased=False)
    return (x - m) / torch.sqrt(v + eps)

def _scatter_add(tgt, idx, src, axis=0):
    return tgt.clone().index_add_(axis, idx, src)

def _segment_sum(src, seg, n):
    out = torch.zeros((n,) + src.shape[1:], dtype=src.dtype)
    return out.index_add_(0, seg, src)

def _pad(x, pw):
    flat = tuple((v for pair in reversed(pw) for v in pair))
    return torch.nn.functional.pad(x, flat)
kernel_name = 'adaLN_cond__compressed_kv_cla__glu_gated_geglu__decode'

def setup_inputs():

    _w = lambda a: (lambda t: t.to(torch.bfloat16) if t.is_floating_point() else t)(torch.as_tensor(a))

    def _A_setup():
        B, H, Sq, Sk, D, M = (4, 32, 1, 4096, 128, 640)
        Dc = 4 * D
        return {'x': _w((lambda *s: torch.randn(*s, dtype=torch.bfloat16) * 0.1)(B, Sq, M)), 'c_kv': _w((lambda *s: torch.randn(*s, dtype=torch.bfloat16) * 6.4)(B, Sk, Dc)), 'w_q': _w((lambda *s: torch.randn(*s, dtype=torch.bfloat16) * 0.8)(M, H, D) * M ** (-0.5)), 'w_uk': _w((lambda *s: torch.randn(*s, dtype=torch.bfloat16) * 0.8)(Dc, H, D) * Dc ** (-0.5)), 'w_uv': _w((lambda *s: torch.randn(*s, dtype=torch.bfloat16) * 6.4)(Dc, H, D) * Dc ** (-0.5)), 'w_o': _w((lambda *s: torch.randn(*s, dtype=torch.bfloat16) * 6.4)(H, D, M) * (H * D) ** (-0.5))}
    _A_in = _A_setup()

    def _B_setup():
        B, S, Dm, Df = (4, 1, 640, 1728)
        return {'x': _w((lambda *s: torch.randn(*s, dtype=torch.bfloat16) * 0.1)(B, S, Dm)), 'w_gate': _w((lambda *s: torch.randn(*s, dtype=torch.bfloat16) * 12.8)(Dm, Df) * Dm ** (-0.5)), 'w_up': _w((lambda *s: torch.randn(*s, dtype=torch.bfloat16) * 12.8)(Dm, Df) * Dm ** (-0.5)), 'w_down': _w((lambda *s: torch.randn(*s, dtype=torch.bfloat16) * 12.8)(Df, Dm) * Df ** (-0.5))}
    _B_in = _B_setup()
    return {'A_x': _A_in['x'], 'A_c_kv': _A_in['c_kv'], 'A_w_q': _A_in['w_q'], 'A_w_uk': _A_in['w_uk'], 'A_w_uv': _A_in['w_uv'], 'A_w_o': _A_in['w_o'], 'B_x': _B_in['x'], 'B_w_gate': _B_in['w_gate'], 'B_w_up': _B_in['w_up'], 'B_w_down': _B_in['w_down'], 'c': _w((lambda *s: torch.randn(*s, dtype=torch.bfloat16) * 0.1)(4, 640) * 8.0), 'w_mod': _w((lambda *s: torch.randn(*s, dtype=torch.bfloat16) * 0.1)(640, 6 * 640) * 640 ** (-0.5) * 8.0)}

def reference(A_x, A_c_kv, A_w_q, A_w_uk, A_w_uv, A_w_o, B_x, B_w_gate, B_w_up, B_w_down, c, w_mod):

    def _A_ref(x, c_kv, w_q, w_uk, w_uv, w_o):
        B, Sq, M = (x.shape[0], x.shape[1], x.shape[2])
        Sk = c_kv.shape[1]
        H, D = (w_q.shape[1], w_q.shape[2])
        q = torch.einsum('bqm,mhd->bhqd', x, w_q)
        k = torch.einsum('bkc,chd->bhkd', c_kv, w_uk)
        v = torch.einsum('bkc,chd->bhkd', c_kv, w_uv)
        scores = torch.einsum('bhqd,bhkd->bhqk', q, k) * D ** (-0.5)
        off = Sk - Sq
        qi = torch.arange(Sq)[:, None]
        kj = torch.arange(Sk)[None, :]
        cmask = kj <= qi + off
        scores = torch.where(cmask[None, None], scores, -1000000000.0)
        p = _softmax(scores, axis=-1)
        ctx = torch.einsum('bhqk,bhkd->bhqd', p, v)
        return torch.einsum('bhqd,hdm->bqm', ctx, w_o)

    def _B_ref(x, w_gate, w_up, w_down):
        g = torch.einsum('bsd,df->bsf', x, w_gate)
        u = torch.einsum('bsd,df->bsf', x, w_up)
        h = _gelu(g) * u
        return torch.einsum('bsf,fd->bsd', h, w_down)
    x = A_x
    mod = (_silu(c) @ w_mod).reshape(c.shape[0], 6, 1, -1)
    sa, ca, ga, sb, cb, gb = (mod[:, 0].clone(), mod[:, 1].clone(), mod[:, 2].clone(), mod[:, 3].clone(), mod[:, 4].clone(), mod[:, 5].clone())
    h = _layernorm(x, axis=-1) * (1 + ca) + sa
    x = x + ga * _A_ref(h, A_c_kv, A_w_q, A_w_uk, A_w_uv, A_w_o)
    h = _layernorm(x, axis=-1) * (1 + cb) + sb
    x = x + gb * _B_ref(h, B_w_gate, B_w_up, B_w_down)
    return x
```

```asm
; @launch grid=(256,1,1) block=(512,1,1) lds=163840
.amdgcn_target "amdgcn-amd-amdhsa--gfx950"
.text
.globl adaLN_cond__compressed_kv_cla__glu_gated_geglu__decode_kernel
.p2align 8
.type adaLN_cond__compressed_kv_cla__glu_gated_geglu__decode_kernel,@function
adaLN_cond__compressed_kv_cla__glu_gated_geglu__decode_kernel:
    s_cmp_ge_u32 s2, 256
    s_cbranch_scc1 L_end
    s_load_dwordx16 s[4:19], s[0:1], 0
    s_load_dwordx8 s[20:27], s[0:1], 64
    s_load_dwordx4 s[28:31], s[0:1], 96
    s_load_dwordx2 s[32:33], s[0:1], 112
    v_lshrrev_b32 v1, 6, v0
    v_and_b32 v0, 63, v0
    s_and_b32 s34, s2, 7
    v_readfirstlane_b32 s3, v1
    s_lshr_b32 s35, s2, 3
    s_add_u32 s42, s35, 24
    s_add_u32 s43, s35, 11
    s_cmp_lt_u32 s35, 5
    s_cselect_b32 s42, s42, s43
    s_add_u32 s43, s35, 16
    s_cmp_ge_u32 s35, 13
    s_cselect_b32 s42, s43, s42
    s_sub_u32 s43, s35, 16
    s_cmp_ge_u32 s35, 16
    s_cselect_b32 s35, s43, s42
    v_and_b32 v1, 15, v0
    v_lshrrev_b32 v2, 4, v0
    v_mov_b32 v61, 163072
    v_mov_b32 v62, 1
    v_mov_b32 v63, 0
    v_lshl_add_u32 v3, v0, 2, v61
    s_cmp_lg_u32 s3, 0
    s_cbranch_scc1 L_noinit
    ds_write_b32 v3, v63
    L_noinit:
    s_mov_b32 s96, 0x000f000f
    s_mov_b32 s97, 0x000f000f
    s_and_b32 s40, s3, 3
    s_lshl_b32 s42, s40, 6
    v_add_u32 v3, s42, v0
    s_waitcnt lgkmcnt(0)
    s_barrier
    s_cmp_ge_u32 s3, 4
    s_cbranch_scc1 L_loader
    s_load_dword s38, s[32:33], 0
    s_setprio 0
    s_cmp_lt_u32 s35, 16
    s_cbranch_scc1 L_A_c
    s_branch L_F_c
    L_loader:
    s_cmp_lt_u32 s35, 16
    s_cbranch_scc1 L_A_l
    s_cmp_lg_u32 s35, 31
    s_cbranch_scc1 L_F_l
    s_cmp_lg_u32 s3, 7
    s_cbranch_scc1 L_F_l
    s_getpc_b64 s[42:43]
    L_pcref:
    v_lshlrev_b32 v20, 4, v0
    s_mov_b32 s44, 0
    L_pf:
    global_load_dwordx4 v[24:27], v20, s[42:43]
    v_add_u32 v20, 1024, v20
    s_add_u32 s44, s44, 1024
    s_cmp_lt_u32 s44, (L_codeend - L_pcref - 1024)
    s_cbranch_scc1 L_pf
    s_branch L_F_l
L_F_l:
    s_sub_u32 s41, s35, 16
    s_lshl_b32 s39, s34, 3
    s_add_u32 s39, s39, s41
    s_mul_i32 s51, s34, 5
    s_add_u32 s51, s51, s41
    s_sub_u32 s51, s51, 8
    s_cmp_lt_u32 s41, 8
    s_cbranch_scc1 L_Y_l
    s_cmp_ge_u32 s41, 13
    s_cbranch_scc1 L_tail_l
    v_lshrrev_b32 v3, 3, v0
    v_and_b32 v4, 7, v0
    v_bfe_u32 v6, v0, 4, 2
    v_lshlrev_b32 v6, 1, v6
    v_xor_b32 v4, v4, v6
    v_lshlrev_b32 v4, 4, v4
    s_mov_b32 s47, 7680
    v_mul_lo_u32 v6, v3, s47
    v_add_u32 v6, v6, v4
    s_lshr_b32 s46, s51, 1
    s_lshl_b32 s46, s46, 7
    s_and_b32 s44, s51, 1
    s_mul_i32 s44, s44, 2457600
    s_add_u32 s46, s46, s44
    s_mul_i32 s44, s40, 614400
    s_add_u32 s46, s46, s44
    s_mul_i32 s47, s40, 10240
    s_add_u32 s42, s26, s46
    s_addc_u32 s43, s27, 0
    s_add_u32 m0, s47, 0
    s_nop 0
    global_load_lds_dwordx4 v6, s[42:43] nt
    s_add_u32 s42, s42, 61440
    s_addc_u32 s43, s43, 0
    s_add_u32 m0, m0, 1024
    s_nop 0
    global_load_lds_dwordx4 v6, s[42:43] nt
    s_add_u32 s42, s42, 61440
    s_addc_u32 s43, s43, 0
    s_add_u32 m0, m0, 1024
    s_nop 0
    global_load_lds_dwordx4 v6, s[42:43] nt
    s_add_u32 s42, s42, 61440
    s_addc_u32 s43, s43, 0
    s_add_u32 m0, m0, 1024
    s_nop 0
    global_load_lds_dwordx4 v6, s[42:43] nt
    s_add_u32 s42, s42, 61440
    s_addc_u32 s43, s43, 0
    s_add_u32 m0, m0, 1024
    s_nop 0
    global_load_lds_dwordx4 v6, s[42:43] nt
    s_add_u32 s42, s42, 61440
    s_addc_u32 s43, s43, 0
    s_add_u32 m0, m0, 1024
    s_nop 0
    global_load_lds_dwordx4 v6, s[42:43] nt
    s_add_u32 s42, s42, 61440
    s_addc_u32 s43, s43, 0
    s_add_u32 m0, m0, 1024
    s_nop 0
    global_load_lds_dwordx4 v6, s[42:43] nt
    s_add_u32 s42, s42, 61440
    s_addc_u32 s43, s43, 0
    s_add_u32 m0, m0, 1024
    s_nop 0
    global_load_lds_dwordx4 v6, s[42:43] nt
    s_add_u32 s42, s42, 61440
    s_addc_u32 s43, s43, 0
    s_add_u32 m0, m0, 1024
    s_nop 0
    global_load_lds_dwordx4 v6, s[42:43] nt
    s_add_u32 s42, s42, 61440
    s_addc_u32 s43, s43, 0
    s_add_u32 m0, m0, 1024
    s_nop 0
    global_load_lds_dwordx4 v6, s[42:43] nt
    s_waitcnt vmcnt(0)
    s_mov_b64 s[100:101], exec
    s_mov_b64 exec, 1
    ds_add_u32 v61, v62 offset:0
    s_mov_b64 exec, s[100:101]
L_lw_20:
    s_sleep 1
    ds_read_b32 v63, v61 offset:20
    s_waitcnt lgkmcnt(0)
    v_readfirstlane_b32 s59, v63
    s_cmp_lt_u32 s59, 4
    s_cbranch_scc1 L_lw_20
    s_branch L_tail_l
L_Y_l:
    s_lshr_b32 s46, s39, 1
    s_lshl_b32 s46, s46, 8
    s_and_b32 s44, s39, 1
    s_mul_i32 s44, s44, 2621440
    s_add_u32 s46, s46, s44
    s_mul_i32 s44, s40, 655360
    s_add_u32 s46, s46, s44
    s_mul_i32 s47, s40, 20480
    v_lshrrev_b32 v3, 4, v0
    v_and_b32 v4, 15, v0
    v_lshlrev_b32 v5, 1, v3
    v_xor_b32 v5, v5, v4
    v_xor_b32 v6, 8, v5
    v_lshlrev_b32 v5, 4, v5
    v_lshlrev_b32 v6, 4, v6
    v_lshl_add_u32 v5, v3, 13, v5
    v_lshl_add_u32 v6, v3, 13, v6
    s_add_u32 s42, s8, s46
    s_addc_u32 s43, s9, 0
    s_add_u32 m0, s47, 0
    s_nop 0
    global_load_lds_dwordx4 v5, s[42:43] nt
    s_add_u32 s42, s42, 32768
    s_addc_u32 s43, s43, 0
    s_add_u32 m0, m0, 1024
    s_nop 0
    global_load_lds_dwordx4 v6, s[42:43] nt
    s_add_u32 s42, s42, 32768
    s_addc_u32 s43, s43, 0
    s_add_u32 m0, m0, 1024
    s_nop 0
    global_load_lds_dwordx4 v5, s[42:43] nt
    s_add_u32 s42, s42, 32768
    s_addc_u32 s43, s43, 0
    s_add_u32 m0, m0, 1024
    s_nop 0
    global_load_lds_dwordx4 v6, s[42:43] nt
    s_add_u32 s42, s42, 32768
    s_addc_u32 s43, s43, 0
    s_add_u32 m0, m0, 1024
    s_nop 0
    global_load_lds_dwordx4 v5, s[42:43] nt
    s_add_u32 s42, s42, 32768
    s_addc_u32 s43, s43, 0
    s_add_u32 m0, m0, 1024
    s_nop 0
    global_load_lds_dwordx4 v6, s[42:43] nt
    s_add_u32 s42, s42, 32768
    s_addc_u32 s43, s43, 0
    s_add_u32 m0, m0, 1024
    s_nop 0
    global_load_lds_dwordx4 v5, s[42:43] nt
    s_add_u32 s42, s42, 32768
    s_addc_u32 s43, s43, 0
    s_add_u32 m0, m0, 1024
    s_nop 0
    global_load_lds_dwordx4 v6, s[42:43] nt
    s_add_u32 s42, s42, 32768
    s_addc_u32 s43, s43, 0
    s_add_u32 m0, m0, 1024
    s_nop 0
    global_load_lds_dwordx4 v5, s[42:43] nt
    s_add_u32 s42, s42, 32768
    s_addc_u32 s43, s43, 0
    s_add_u32 m0, m0, 1024
    s_nop 0
    global_load_lds_dwordx4 v6, s[42:43] nt
    s_add_u32 s42, s42, 32768
    s_addc_u32 s43, s43, 0
    s_add_u32 m0, m0, 1024
    s_nop 0
    global_load_lds_dwordx4 v5, s[42:43] nt
    s_add_u32 s42, s42, 32768
    s_addc_u32 s43, s43, 0
    s_add_u32 m0, m0, 1024
    s_nop 0
    global_load_lds_dwordx4 v6, s[42:43] nt
    s_add_u32 s42, s42, 32768
    s_addc_u32 s43, s43, 0
    s_add_u32 m0, m0, 1024
    s_nop 0
    global_load_lds_dwordx4 v5, s[42:43] nt
    s_add_u32 s42, s42, 32768
    s_addc_u32 s43, s43, 0
    s_add_u32 m0, m0, 1024
    s_nop 0
    global_load_lds_dwordx4 v6, s[42:43] nt
    s_add_u32 s42, s42, 32768
    s_addc_u32 s43, s43, 0
    s_add_u32 m0, m0, 1024
    s_nop 0
    global_load_lds_dwordx4 v5, s[42:43] nt
    s_add_u32 s42, s42, 32768
    s_addc_u32 s43, s43, 0
    s_add_u32 m0, m0, 1024
    s_nop 0
    global_load_lds_dwordx4 v6, s[42:43] nt
    s_add_u32 s42, s42, 32768
    s_addc_u32 s43, s43, 0
    s_add_u32 m0, m0, 1024
    s_nop 0
    global_load_lds_dwordx4 v5, s[42:43] nt
    s_add_u32 s42, s42, 32768
    s_addc_u32 s43, s43, 0
    s_add_u32 m0, m0, 1024
    s_nop 0
    global_load_lds_dwordx4 v6, s[42:43] nt
    s_add_u32 s42, s42, 32768
    s_addc_u32 s43, s43, 0
    s_add_u32 m0, m0, 1024
    s_nop 0
    global_load_lds_dwordx4 v5, s[42:43] nt
    s_add_u32 s42, s42, 32768
    s_addc_u32 s43, s43, 0
    s_add_u32 m0, m0, 1024
    s_nop 0
    global_load_lds_dwordx4 v6, s[42:43] nt
    s_lshr_b32 s46, s39, 1
    s_lshl_b32 s46, s46, 8
    s_and_b32 s44, s39, 1
    s_lshl_b32 s44, s44, 21
    s_add_u32 s46, s46, s44
    s_lshl_b32 s44, s40, 19
    s_add_u32 s46, s46, s44
    s_lshl_b32 s47, s40, 14
    v_lshrrev_b32 v3, 4, v0
    v_and_b32 v4, 15, v0
    v_xor_b32 v4, v4, v3
    v_xor_b32 v8, 0, v4
    v_lshlrev_b32 v8, 4, v8
    v_lshl_add_u32 v8, v3, 13, v8
    v_xor_b32 v9, 4, v4
    v_lshlrev_b32 v9, 4, v9
    v_lshl_add_u32 v9, v3, 13, v9
    v_xor_b32 v10, 8, v4
    v_lshlrev_b32 v10, 4, v10
    v_lshl_add_u32 v10, v3, 13, v10
    v_xor_b32 v11, 12, v4
    v_lshlrev_b32 v11, 4, v11
    v_lshl_add_u32 v11, v3, 13, v11
    s_add_u32 s42, s10, s46
    s_addc_u32 s43, s11, 0
    s_add_u32 m0, s47, 81920
    s_nop 0
    global_load_lds_dwordx4 v8, s[42:43] nt
    s_add_u32 s42, s42, 32768
    s_addc_u32 s43, s43, 0
    s_add_u32 m0, m0, 1024
    s_nop 0
    global_load_lds_dwordx4 v9, s[42:43] nt
    s_add_u32 s42, s42, 32768
    s_addc_u32 s43, s43, 0
    s_add_u32 m0, m0, 1024
    s_nop 0
    global_load_lds_dwordx4 v10, s[42:43] nt
    s_add_u32 s42, s42, 32768
    s_addc_u32 s43, s43, 0
    s_add_u32 m0, m0, 1024
    s_nop 0
    global_load_lds_dwordx4 v11, s[42:43] nt
    s_add_u32 s46, s46, 131072
    s_add_u32 s47, s47, 4096
    s_waitcnt vmcnt(4)
    s_mov_b64 s[100:101], exec
    s_mov_b64 exec, 1
    ds_add_u32 v61, v62 offset:8
    s_mov_b64 exec, s[100:101]
L_lw_22:
    s_sleep 1
    ds_read_b32 v63, v61 offset:92
    s_waitcnt lgkmcnt(0)
    v_readfirstlane_b32 s59, v63
    s_cmp_lt_u32 s59, 4
    s_cbranch_scc1 L_lw_22
    s_add_u32 s42, s10, s46
    s_addc_u32 s43, s11, 0
    s_add_u32 m0, s47, 81920
    s_nop 0
    global_load_lds_dwordx4 v8, s[42:43] nt
    s_add_u32 s42, s42, 32768
    s_addc_u32 s43, s43, 0
    s_add_u32 m0, m0, 1024
    s_nop 0
    global_load_lds_dwordx4 v9, s[42:43] nt
    s_add_u32 s42, s42, 32768
    s_addc_u32 s43, s43, 0
    s_add_u32 m0, m0, 1024
    s_nop 0
    global_load_lds_dwordx4 v10, s[42:43] nt
    s_add_u32 s42, s42, 32768
    s_addc_u32 s43, s43, 0
    s_add_u32 m0, m0, 1024
    s_nop 0
    global_load_lds_dwordx4 v11, s[42:43] nt
    s_add_u32 s42, s42, 32768
    s_addc_u32 s43, s43, 0
    s_add_u32 m0, m0, 1024
    s_nop 0
    global_load_lds_dwordx4 v8, s[42:43] nt
    s_add_u32 s42, s42, 32768
    s_addc_u32 s43, s43, 0
    s_add_u32 m0, m0, 1024
    s_nop 0
    global_load_lds_dwordx4 v9, s[42:43] nt
    s_add_u32 s42, s42, 32768
    s_addc_u32 s43, s43, 0
    s_add_u32 m0, m0, 1024
    s_nop 0
    global_load_lds_dwordx4 v10, s[42:43] nt
    s_add_u32 s42, s42, 32768
    s_addc_u32 s43, s43, 0
    s_add_u32 m0, m0, 1024
    s_nop 0
    global_load_lds_dwordx4 v11, s[42:43] nt
    s_add_u32 s42, s42, 32768
    s_addc_u32 s43, s43, 0
    s_add_u32 m0, m0, 1024
    s_nop 0
    global_load_lds_dwordx4 v8, s[42:43] nt
    s_add_u32 s42, s42, 32768
    s_addc_u32 s43, s43, 0
    s_add_u32 m0, m0, 1024
    s_nop 0
    global_load_lds_dwordx4 v9, s[42:43] nt
    s_add_u32 s42, s42, 32768
    s_addc_u32 s43, s43, 0
    s_add_u32 m0, m0, 1024
    s_nop 0
    global_load_lds_dwordx4 v10, s[42:43] nt
    s_add_u32 s42, s42, 32768
    s_addc_u32 s43, s43, 0
    s_add_u32 m0, m0, 1024
    s_nop 0
    global_load_lds_dwordx4 v11, s[42:43] nt
    s_waitcnt vmcnt(0)
    s_mov_b64 s[100:101], exec
    s_mov_b64 exec, 1
    ds_add_u32 v61, v62 offset:16
    s_mov_b64 exec, s[100:101]
L_lw_23:
    s_sleep 1
    ds_read_b32 v63, v61 offset:88
    s_waitcnt lgkmcnt(0)
    v_readfirstlane_b32 s59, v63
    s_cmp_lt_u32 s59, 4
    s_cbranch_scc1 L_lw_23
    s_branch L_tail_l
L_tail_l:
    s_cmp_lt_u32 s41, 13
    s_cbranch_scc1 L_pf_32
    s_sub_u32 s44, s41, 13
    s_cmp_eq_u32 s44, 0
    s_cselect_b32 s45, 1, 0
    s_cmp_eq_u32 s44, 2
    s_cselect_b32 s45, 2, s45
    s_lshl_b32 s46, s34, 2
    s_add_u32 s46, s46, s45
    s_lshl_b32 s46, s46, 8
    s_lshl_b32 s47, s40, 20
    s_add_u32 s46, s46, s47
    s_lshl_b32 s47, s40, 15
    v_lshrrev_b32 v3, 4, v0
    v_and_b32 v4, 15, v0
    v_lshlrev_b32 v4, 4, v4
    v_lshl_add_u32 v8, v3, 13, v4
    s_add_u32 s42, s10, s46
    s_addc_u32 s43, s11, 0
    s_add_u32 m0, s47, 0
    s_nop 0
    global_load_lds_dwordx4 v8, s[42:43] nt
    s_add_u32 s42, s42, 32768
    s_addc_u32 s43, s43, 0
    s_add_u32 m0, m0, 1024
    s_nop 0
    global_load_lds_dwordx4 v8, s[42:43] nt
    s_add_u32 s42, s42, 32768
    s_addc_u32 s43, s43, 0
    s_add_u32 m0, m0, 1024
    s_nop 0
    global_load_lds_dwordx4 v8, s[42:43] nt
    s_add_u32 s42, s42, 32768
    s_addc_u32 s43, s43, 0
    s_add_u32 m0, m0, 1024
    s_nop 0
    global_load_lds_dwordx4 v8, s[42:43] nt
    s_add_u32 s42, s42, 32768
    s_addc_u32 s43, s43, 0
    s_add_u32 m0, m0, 1024
    s_nop 0
    global_load_lds_dwordx4 v8, s[42:43] nt
    s_add_u32 s42, s42, 32768
    s_addc_u32 s43, s43, 0
    s_add_u32 m0, m0, 1024
    s_nop 0
    global_load_lds_dwordx4 v8, s[42:43] nt
    s_add_u32 s42, s42, 32768
    s_addc_u32 s43, s43, 0
    s_add_u32 m0, m0, 1024
    s_nop 0
    global_load_lds_dwordx4 v8, s[42:43] nt
    s_add_u32 s42, s42, 32768
    s_addc_u32 s43, s43, 0
    s_add_u32 m0, m0, 1024
    s_nop 0
    global_load_lds_dwordx4 v8, s[42:43] nt
    s_add_u32 s42, s42, 32768
    s_addc_u32 s43, s43, 0
    s_add_u32 m0, m0, 1024
    s_nop 0
    global_load_lds_dwordx4 v8, s[42:43] nt
    s_add_u32 s42, s42, 32768
    s_addc_u32 s43, s43, 0
    s_add_u32 m0, m0, 1024
    s_nop 0
    global_load_lds_dwordx4 v8, s[42:43] nt
    s_add_u32 s42, s42, 32768
    s_addc_u32 s43, s43, 0
    s_add_u32 m0, m0, 1024
    s_nop 0
    global_load_lds_dwordx4 v8, s[42:43] nt
    s_add_u32 s42, s42, 32768
    s_addc_u32 s43, s43, 0
    s_add_u32 m0, m0, 1024
    s_nop 0
    global_load_lds_dwordx4 v8, s[42:43] nt
    s_add_u32 s42, s42, 32768
    s_addc_u32 s43, s43, 0
    s_add_u32 m0, m0, 1024
    s_nop 0
    global_load_lds_dwordx4 v8, s[42:43] nt
    s_add_u32 s42, s42, 32768
    s_addc_u32 s43, s43, 0
    s_add_u32 m0, m0, 1024
    s_nop 0
    global_load_lds_dwordx4 v8, s[42:43] nt
    s_add_u32 s42, s42, 32768
    s_addc_u32 s43, s43, 0
    s_add_u32 m0, m0, 1024
    s_nop 0
    global_load_lds_dwordx4 v8, s[42:43] nt
    s_add_u32 s42, s42, 32768
    s_addc_u32 s43, s43, 0
    s_add_u32 m0, m0, 1024
    s_nop 0
    global_load_lds_dwordx4 v8, s[42:43] nt
    s_add_u32 s42, s42, 32768
    s_addc_u32 s43, s43, 0
    s_add_u32 m0, m0, 1024
    s_nop 0
    global_load_lds_dwordx4 v8, s[42:43] nt
    s_add_u32 s42, s42, 32768
    s_addc_u32 s43, s43, 0
    s_add_u32 m0, m0, 1024
    s_nop 0
    global_load_lds_dwordx4 v8, s[42:43] nt
    s_add_u32 s42, s42, 32768
    s_addc_u32 s43, s43, 0
    s_add_u32 m0, m0, 1024
    s_nop 0
    global_load_lds_dwordx4 v8, s[42:43] nt
    s_add_u32 s42, s42, 32768
    s_addc_u32 s43, s43, 0
    s_add_u32 m0, m0, 1024
    s_nop 0
    global_load_lds_dwordx4 v8, s[42:43] nt
    s_add_u32 s42, s42, 32768
    s_addc_u32 s43, s43, 0
    s_add_u32 m0, m0, 1024
    s_nop 0
    global_load_lds_dwordx4 v8, s[42:43] nt
    s_add_u32 s42, s42, 32768
    s_addc_u32 s43, s43, 0
    s_add_u32 m0, m0, 1024
    s_nop 0
    global_load_lds_dwordx4 v8, s[42:43] nt
    s_add_u32 s42, s42, 32768
    s_addc_u32 s43, s43, 0
    s_add_u32 m0, m0, 1024
    s_nop 0
    global_load_lds_dwordx4 v8, s[42:43] nt
    s_add_u32 s42, s42, 32768
    s_addc_u32 s43, s43, 0
    s_add_u32 m0, m0, 1024
    s_nop 0
    global_load_lds_dwordx4 v8, s[42:43] nt
    s_add_u32 s42, s42, 32768
    s_addc_u32 s43, s43, 0
    s_add_u32 m0, m0, 1024
    s_nop 0
    global_load_lds_dwordx4 v8, s[42:43] nt
    s_add_u32 s42, s42, 32768
    s_addc_u32 s43, s43, 0
    s_add_u32 m0, m0, 1024
    s_nop 0
    global_load_lds_dwordx4 v8, s[42:43] nt
    s_add_u32 s42, s42, 32768
    s_addc_u32 s43, s43, 0
    s_add_u32 m0, m0, 1024
    s_nop 0
    global_load_lds_dwordx4 v8, s[42:43] nt
    s_add_u32 s42, s42, 32768
    s_addc_u32 s43, s43, 0
    s_add_u32 m0, m0, 1024
    s_nop 0
    global_load_lds_dwordx4 v8, s[42:43] nt
    s_add_u32 s42, s42, 32768
    s_addc_u32 s43, s43, 0
    s_add_u32 m0, m0, 1024
    s_nop 0
    global_load_lds_dwordx4 v8, s[42:43] nt
    s_add_u32 s42, s42, 32768
    s_addc_u32 s43, s43, 0
    s_add_u32 m0, m0, 1024
    s_nop 0
    global_load_lds_dwordx4 v8, s[42:43] nt
    s_add_u32 s42, s42, 32768
    s_addc_u32 s43, s43, 0
    s_add_u32 m0, m0, 1024
    s_nop 0
    global_load_lds_dwordx4 v8, s[42:43] nt
    s_add_u32 s42, s42, 32768
    s_addc_u32 s43, s43, 0
    s_add_u32 m0, m0, 1024
    s_nop 0
    global_load_lds_dwordx4 v8, s[42:43] nt
    s_cmp_eq_u32 s41, 13
    s_cbranch_scc1 L_pf2_33
    s_lshl_b32 s46, s34, 2
    s_add_u32 s46, s46, 3
    s_lshl_b32 s46, s46, 8
    s_sub_u32 s44, s41, 14
    s_lshl_b32 s44, s44, 21
    s_add_u32 s46, s46, s44
    s_lshl_b32 s44, s40, 19
    s_add_u32 s46, s46, s44
    s_lshl_b32 s47, s40, 14
    s_add_u32 s42, s10, s46
    s_addc_u32 s43, s11, 0
    s_add_u32 m0, s47, 0
    s_nop 0
    global_load_lds_dwordx4 v8, s[42:43] nt
    s_add_u32 s42, s42, 32768
    s_addc_u32 s43, s43, 0
    s_add_u32 m0, m0, 1024
    s_nop 0
    global_load_lds_dwordx4 v8, s[42:43] nt
    s_add_u32 s42, s42, 32768
    s_addc_u32 s43, s43, 0
    s_add_u32 m0, m0, 1024
    s_nop 0
    global_load_lds_dwordx4 v8, s[42:43] nt
    s_add_u32 s42, s42, 32768
    s_addc_u32 s43, s43, 0
    s_add_u32 m0, m0, 1024
    s_nop 0
    global_load_lds_dwordx4 v8, s[42:43] nt
    s_add_u32 s42, s42, 32768
    s_addc_u32 s43, s43, 0
    s_add_u32 m0, m0, 1024
    s_nop 0
    global_load_lds_dwordx4 v8, s[42:43] nt
    s_add_u32 s42, s42, 32768
    s_addc_u32 s43, s43, 0
    s_add_u32 m0, m0, 1024
    s_nop 0
    global_load_lds_dwordx4 v8, s[42:43] nt
    s_add_u32 s42, s42, 32768
    s_addc_u32 s43, s43, 0
    s_add_u32 m0, m0, 1024
    s_nop 0
    global_load_lds_dwordx4 v8, s[42:43] nt
    s_add_u32 s42, s42, 32768
    s_addc_u32 s43, s43, 0
    s_add_u32 m0, m0, 1024
    s_nop 0
    global_load_lds_dwordx4 v8, s[42:43] nt
    s_add_u32 s42, s42, 32768
    s_addc_u32 s43, s43, 0
    s_add_u32 m0, m0, 1024
    s_nop 0
    global_load_lds_dwordx4 v8, s[42:43] nt
    s_add_u32 s42, s42, 32768
    s_addc_u32 s43, s43, 0
    s_add_u32 m0, m0, 1024
    s_nop 0
    global_load_lds_dwordx4 v8, s[42:43] nt
    s_add_u32 s42, s42, 32768
    s_addc_u32 s43, s43, 0
    s_add_u32 m0, m0, 1024
    s_nop 0
    global_load_lds_dwordx4 v8, s[42:43] nt
    s_add_u32 s42, s42, 32768
    s_addc_u32 s43, s43, 0
    s_add_u32 m0, m0, 1024
    s_nop 0
    global_load_lds_dwordx4 v8, s[42:43] nt
    s_add_u32 s42, s42, 32768
    s_addc_u32 s43, s43, 0
    s_add_u32 m0, m0, 1024
    s_nop 0
    global_load_lds_dwordx4 v8, s[42:43] nt
    s_add_u32 s42, s42, 32768
    s_addc_u32 s43, s43, 0
    s_add_u32 m0, m0, 1024
    s_nop 0
    global_load_lds_dwordx4 v8, s[42:43] nt
    s_add_u32 s42, s42, 32768
    s_addc_u32 s43, s43, 0
    s_add_u32 m0, m0, 1024
    s_nop 0
    global_load_lds_dwordx4 v8, s[42:43] nt
    s_add_u32 s42, s42, 32768
    s_addc_u32 s43, s43, 0
    s_add_u32 m0, m0, 1024
    s_nop 0
    global_load_lds_dwordx4 v8, s[42:43] nt
L_pf2_33:
    s_waitcnt vmcnt(0)
L_pf_32:
    s_cmp_lt_u32 s41, 8
    s_cbranch_scc1 L_ft_34
    s_load_dword s38, s[32:33], 0
    v_mov_b32 v20, 156672
    s_mov_b32 s50, 0
    s_waitcnt lgkmcnt(0)
    s_add_u32 s36, s38, 1
    L_tg_35:
    global_load_dword v21, v20, s[32:33] offset:8 sc1
    s_add_u32 s50, s50, 1
    s_waitcnt vmcnt(0)
    v_readfirstlane_b32 s59, v21
    s_cmp_ge_u32 s50, 262144
    s_cbranch_scc1 L_tgd_36
    s_cmp_eq_u32 s59, s36
    s_cbranch_scc1 L_tgd_36
    s_sleep 2
    s_branch L_tg_35
    L_tgd_36:
L_ft_34:
    s_mul_i32 s51, s34, 5
    s_add_u32 s51, s51, s41
    s_mul_i32 s54, s34, 7
    s_add_u32 s54, s54, s41
    s_cmp_lt_u32 s41, 7
    s_cbranch_scc1 L_T6_l
    s_cmp_lt_u32 s41, 8
    s_cbranch_scc1 L_fin
    s_sub_u32 s51, s51, 11
    s_mul_i32 s54, s34, 3
    s_add_u32 s54, s54, s41
    s_sub_u32 s54, s54, 8
    s_cmp_lt_u32 s41, 11
    s_cbranch_scc1 L_T7_l
    s_branch L_T5_l
L_T6_l:
    s_cmp_ge_u32 s54, 54
    s_cbranch_scc1 L_fin
    v_lshrrev_b32 v3, 3, v0
    v_and_b32 v4, 7, v0
    v_bfe_u32 v6, v0, 4, 2
    v_lshlrev_b32 v6, 1, v6
    v_xor_b32 v4, v4, v6
    v_lshlrev_b32 v4, 4, v4
    s_mov_b32 s47, 7680
    v_mul_lo_u32 v6, v3, s47
    v_add_u32 v6, v6, v4
    v_lshrrev_b32 v3, 2, v0
    v_and_b32 v4, 3, v0
    v_bfe_u32 v5, v0, 4, 1
    v_lshlrev_b32 v5, 1, v5
    v_xor_b32 v4, v4, v5
    v_lshlrev_b32 v4, 4, v4
    s_mov_b32 s47, 3456
    v_mul_lo_u32 v5, v3, s47
    v_add_u32 v5, v5, v4
    s_cmp_ge_u32 s41, 5
    s_cbranch_scc1 L_F_no0n
    s_lshl_b32 s46, s51, 7
    s_add_u32 s46, s46, 2560
    s_mul_i32 s44, s40, 1228800
    s_add_u32 s46, s46, s44
    s_mul_i32 s47, s40, 20480
    s_add_u32 s42, s26, s46
    s_addc_u32 s43, s27, 0
    s_add_u32 m0, s47, 0
    s_nop 0
    global_load_lds_dwordx4 v6, s[42:43] nt
    s_add_u32 s42, s42, 61440
    s_addc_u32 s43, s43, 0
    s_add_u32 m0, m0, 1024
    s_nop 0
    global_load_lds_dwordx4 v6, s[42:43] nt
    s_add_u32 s42, s42, 61440
    s_addc_u32 s43, s43, 0
    s_add_u32 m0, m0, 1024
    s_nop 0
    global_load_lds_dwordx4 v6, s[42:43] nt
    s_add_u32 s42, s42, 61440
    s_addc_u32 s43, s43, 0
    s_add_u32 m0, m0, 1024
    s_nop 0
    global_load_lds_dwordx4 v6, s[42:43] nt
    s_add_u32 s42, s42, 61440
    s_addc_u32 s43, s43, 0
    s_add_u32 m0, m0, 1024
    s_nop 0
    global_load_lds_dwordx4 v6, s[42:43] nt
    s_add_u32 s42, s42, 61440
    s_addc_u32 s43, s43, 0
    s_add_u32 m0, m0, 1024
    s_nop 0
    global_load_lds_dwordx4 v6, s[42:43] nt
    s_add_u32 s42, s42, 61440
    s_addc_u32 s43, s43, 0
    s_add_u32 m0, m0, 1024
    s_nop 0
    global_load_lds_dwordx4 v6, s[42:43] nt
    s_add_u32 s42, s42, 61440
    s_addc_u32 s43, s43, 0
    s_add_u32 m0, m0, 1024
    s_nop 0
    global_load_lds_dwordx4 v6, s[42:43] nt
    s_add_u32 s42, s42, 61440
    s_addc_u32 s43, s43, 0
    s_add_u32 m0, m0, 1024
    s_nop 0
    global_load_lds_dwordx4 v6, s[42:43] nt
    s_add_u32 s42, s42, 61440
    s_addc_u32 s43, s43, 0
    s_add_u32 m0, m0, 1024
    s_nop 0
    global_load_lds_dwordx4 v6, s[42:43] nt
    s_add_u32 s42, s42, 61440
    s_addc_u32 s43, s43, 0
    s_add_u32 m0, m0, 1024
    s_nop 0
    global_load_lds_dwordx4 v6, s[42:43] nt
    s_add_u32 s42, s42, 61440
    s_addc_u32 s43, s43, 0
    s_add_u32 m0, m0, 1024
    s_nop 0
    global_load_lds_dwordx4 v6, s[42:43] nt
    s_add_u32 s42, s42, 61440
    s_addc_u32 s43, s43, 0
    s_add_u32 m0, m0, 1024
    s_nop 0
    global_load_lds_dwordx4 v6, s[42:43] nt
    s_add_u32 s42, s42, 61440
    s_addc_u32 s43, s43, 0
    s_add_u32 m0, m0, 1024
    s_nop 0
    global_load_lds_dwordx4 v6, s[42:43] nt
    s_add_u32 s42, s42, 61440
    s_addc_u32 s43, s43, 0
    s_add_u32 m0, m0, 1024
    s_nop 0
    global_load_lds_dwordx4 v6, s[42:43] nt
    s_add_u32 s42, s42, 61440
    s_addc_u32 s43, s43, 0
    s_add_u32 m0, m0, 1024
    s_nop 0
    global_load_lds_dwordx4 v6, s[42:43] nt
    s_add_u32 s42, s42, 61440
    s_addc_u32 s43, s43, 0
    s_add_u32 m0, m0, 1024
    s_nop 0
    global_load_lds_dwordx4 v6, s[42:43] nt
    s_add_u32 s42, s42, 61440
    s_addc_u32 s43, s43, 0
    s_add_u32 m0, m0, 1024
    s_nop 0
    global_load_lds_dwordx4 v6, s[42:43] nt
    s_add_u32 s42, s42, 61440
    s_addc_u32 s43, s43, 0
    s_add_u32 m0, m0, 1024
    s_nop 0
    global_load_lds_dwordx4 v6, s[42:43] nt
    s_add_u32 s42, s42, 61440
    s_addc_u32 s43, s43, 0
    s_add_u32 m0, m0, 1024
    s_nop 0
    global_load_lds_dwordx4 v6, s[42:43] nt
    s_waitcnt vmcnt(0)
    s_mov_b64 s[100:101], exec
    s_mov_b64 exec, 1
    ds_add_u32 v61, v62 offset:72
    s_mov_b64 exec, s[100:101]
L_lw_37:
    s_sleep 1
    ds_read_b32 v63, v61 offset:76
    s_waitcnt lgkmcnt(0)
    v_readfirstlane_b32 s59, v63
    s_cmp_lt_u32 s59, 4
    s_cbranch_scc1 L_lw_37
L_F_no0n:
    s_lshl_b32 s46, s54, 6
    s_and_b32 s44, s40, 1
    s_mul_i32 s44, s44, 1105920
    s_add_u32 s46, s46, s44
    s_cmp_ge_u32 s40, 2
    s_cselect_b32 s56, s20, s18
    s_cselect_b32 s57, s21, s19
    s_mul_i32 s47, s40, 20480
    s_add_u32 s42, s56, s46
    s_addc_u32 s43, s57, 0
    s_add_u32 m0, s47, 0
    s_nop 0
    global_load_lds_dwordx4 v5, s[42:43] nt
    s_add_u32 s42, s42, 55296
    s_addc_u32 s43, s43, 0
    s_add_u32 m0, m0, 1024
    s_nop 0
    global_load_lds_dwordx4 v5, s[42:43] nt
    s_add_u32 s42, s42, 55296
    s_addc_u32 s43, s43, 0
    s_add_u32 m0, m0, 1024
    s_nop 0
    global_load_lds_dwordx4 v5, s[42:43] nt
    s_add_u32 s42, s42, 55296
    s_addc_u32 s43, s43, 0
    s_add_u32 m0, m0, 1024
    s_nop 0
    global_load_lds_dwordx4 v5, s[42:43] nt
    s_add_u32 s42, s42, 55296
    s_addc_u32 s43, s43, 0
    s_add_u32 m0, m0, 1024
    s_nop 0
    global_load_lds_dwordx4 v5, s[42:43] nt
    s_add_u32 s42, s42, 55296
    s_addc_u32 s43, s43, 0
    s_add_u32 m0, m0, 1024
    s_nop 0
    global_load_lds_dwordx4 v5, s[42:43] nt
    s_add_u32 s42, s42, 55296
    s_addc_u32 s43, s43, 0
    s_add_u32 m0, m0, 1024
    s_nop 0
    global_load_lds_dwordx4 v5, s[42:43] nt
    s_add_u32 s42, s42, 55296
    s_addc_u32 s43, s43, 0
    s_add_u32 m0, m0, 1024
    s_nop 0
    global_load_lds_dwordx4 v5, s[42:43] nt
    s_add_u32 s42, s42, 55296
    s_addc_u32 s43, s43, 0
    s_add_u32 m0, m0, 1024
    s_nop 0
    global_load_lds_dwordx4 v5, s[42:43] nt
    s_add_u32 s42, s42, 55296
    s_addc_u32 s43, s43, 0
    s_add_u32 m0, m0, 1024
    s_nop 0
    global_load_lds_dwordx4 v5, s[42:43] nt
    s_add_u32 s42, s42, 55296
    s_addc_u32 s43, s43, 0
    s_add_u32 m0, m0, 1024
    s_nop 0
    global_load_lds_dwordx4 v5, s[42:43] nt
    s_add_u32 s42, s42, 55296
    s_addc_u32 s43, s43, 0
    s_add_u32 m0, m0, 1024
    s_nop 0
    global_load_lds_dwordx4 v5, s[42:43] nt
    s_add_u32 s42, s42, 55296
    s_addc_u32 s43, s43, 0
    s_add_u32 m0, m0, 1024
    s_nop 0
    global_load_lds_dwordx4 v5, s[42:43] nt
    s_add_u32 s42, s42, 55296
    s_addc_u32 s43, s43, 0
    s_add_u32 m0, m0, 1024
    s_nop 0
    global_load_lds_dwordx4 v5, s[42:43] nt
    s_add_u32 s42, s42, 55296
    s_addc_u32 s43, s43, 0
    s_add_u32 m0, m0, 1024
    s_nop 0
    global_load_lds_dwordx4 v5, s[42:43] nt
    s_add_u32 s42, s42, 55296
    s_addc_u32 s43, s43, 0
    s_add_u32 m0, m0, 1024
    s_nop 0
    global_load_lds_dwordx4 v5, s[42:43] nt
    s_add_u32 s42, s42, 55296
    s_addc_u32 s43, s43, 0
    s_add_u32 m0, m0, 1024
    s_nop 0
    global_load_lds_dwordx4 v5, s[42:43] nt
    s_add_u32 s42, s42, 55296
    s_addc_u32 s43, s43, 0
    s_add_u32 m0, m0, 1024
    s_nop 0
    global_load_lds_dwordx4 v5, s[42:43] nt
    s_add_u32 s42, s42, 55296
    s_addc_u32 s43, s43, 0
    s_add_u32 m0, m0, 1024
    s_nop 0
    global_load_lds_dwordx4 v5, s[42:43] nt
    s_add_u32 s42, s42, 55296
    s_addc_u32 s43, s43, 0
    s_add_u32 m0, m0, 1024
    s_nop 0
    global_load_lds_dwordx4 v5, s[42:43] nt
    s_waitcnt vmcnt(0)
    s_mov_b64 s[100:101], exec
    s_mov_b64 exec, 1
    ds_add_u32 v61, v62 offset:52
    s_mov_b64 exec, s[100:101]
    s_branch L_fin
L_T5_l:
    v_lshrrev_b32 v3, 2, v0
    v_and_b32 v4, 3, v0
    v_bfe_u32 v5, v0, 4, 1
    v_lshlrev_b32 v5, 1, v5
    v_xor_b32 v4, v4, v5
    v_lshlrev_b32 v4, 4, v4
    s_mov_b32 s47, 1280
    v_mul_lo_u32 v5, v3, s47
    v_add_u32 v5, v5, v4
    s_lshr_b32 s46, s51, 1
    s_lshl_b32 s46, s46, 6
    s_and_b32 s44, s51, 1
    s_mul_i32 s44, s44, 2621440
    s_add_u32 s46, s46, s44
    s_mul_i32 s44, s40, 655360
    s_add_u32 s46, s46, s44
    s_lshl_b32 s47, s40, 15
    s_add_u32 s42, s14, s46
    s_addc_u32 s43, s15, 0
    s_add_u32 m0, s47, 0
    s_nop 0
    global_load_lds_dwordx4 v5, s[42:43] nt
    s_add_u32 s42, s42, 20480
    s_addc_u32 s43, s43, 0
    s_add_u32 m0, m0, 1024
    s_nop 0
    global_load_lds_dwordx4 v5, s[42:43] nt
    s_add_u32 s42, s42, 20480
    s_addc_u32 s43, s43, 0
    s_add_u32 m0, m0, 1024
    s_nop 0
    global_load_lds_dwordx4 v5, s[42:43] nt
    s_add_u32 s42, s42, 20480
    s_addc_u32 s43, s43, 0
    s_add_u32 m0, m0, 1024
    s_nop 0
    global_load_lds_dwordx4 v5, s[42:43] nt
    s_add_u32 s42, s42, 20480
    s_addc_u32 s43, s43, 0
    s_add_u32 m0, m0, 1024
    s_nop 0
    global_load_lds_dwordx4 v5, s[42:43] nt
    s_add_u32 s42, s42, 20480
    s_addc_u32 s43, s43, 0
    s_add_u32 m0, m0, 1024
    s_nop 0
    global_load_lds_dwordx4 v5, s[42:43] nt
    s_add_u32 s42, s42, 20480
    s_addc_u32 s43, s43, 0
    s_add_u32 m0, m0, 1024
    s_nop 0
    global_load_lds_dwordx4 v5, s[42:43] nt
    s_add_u32 s42, s42, 20480
    s_addc_u32 s43, s43, 0
    s_add_u32 m0, m0, 1024
    s_nop 0
    global_load_lds_dwordx4 v5, s[42:43] nt
    s_add_u32 s42, s42, 20480
    s_addc_u32 s43, s43, 0
    s_add_u32 m0, m0, 1024
    s_nop 0
    global_load_lds_dwordx4 v5, s[42:43] nt
    s_add_u32 s42, s42, 20480
    s_addc_u32 s43, s43, 0
    s_add_u32 m0, m0, 1024
    s_nop 0
    global_load_lds_dwordx4 v5, s[42:43] nt
    s_add_u32 s42, s42, 20480
    s_addc_u32 s43, s43, 0
    s_add_u32 m0, m0, 1024
    s_nop 0
    global_load_lds_dwordx4 v5, s[42:43] nt
    s_add_u32 s42, s42, 20480
    s_addc_u32 s43, s43, 0
    s_add_u32 m0, m0, 1024
    s_nop 0
    global_load_lds_dwordx4 v5, s[42:43] nt
    s_add_u32 s42, s42, 20480
    s_addc_u32 s43, s43, 0
    s_add_u32 m0, m0, 1024
    s_nop 0
    global_load_lds_dwordx4 v5, s[42:43] nt
    s_add_u32 s42, s42, 20480
    s_addc_u32 s43, s43, 0
    s_add_u32 m0, m0, 1024
    s_nop 0
    global_load_lds_dwordx4 v5, s[42:43] nt
    s_add_u32 s42, s42, 20480
    s_addc_u32 s43, s43, 0
    s_add_u32 m0, m0, 1024
    s_nop 0
    global_load_lds_dwordx4 v5, s[42:43] nt
    s_add_u32 s42, s42, 20480
    s_addc_u32 s43, s43, 0
    s_add_u32 m0, m0, 1024
    s_nop 0
    global_load_lds_dwordx4 v5, s[42:43] nt
    s_add_u32 s42, s42, 20480
    s_addc_u32 s43, s43, 0
    s_add_u32 m0, m0, 1024
    s_nop 0
    global_load_lds_dwordx4 v5, s[42:43] nt
    s_add_u32 s42, s42, 20480
    s_addc_u32 s43, s43, 0
    s_add_u32 m0, m0, 1024
    s_nop 0
    global_load_lds_dwordx4 v5, s[42:43] nt
    s_add_u32 s42, s42, 20480
    s_addc_u32 s43, s43, 0
    s_add_u32 m0, m0, 1024
    s_nop 0
    global_load_lds_dwordx4 v5, s[42:43] nt
    s_add_u32 s42, s42, 20480
    s_addc_u32 s43, s43, 0
    s_add_u32 m0, m0, 1024
    s_nop 0
    global_load_lds_dwordx4 v5, s[42:43] nt
    s_add_u32 s42, s42, 20480
    s_addc_u32 s43, s43, 0
    s_add_u32 m0, m0, 1024
    s_nop 0
    global_load_lds_dwordx4 v5, s[42:43] nt
    s_add_u32 s42, s42, 20480
    s_addc_u32 s43, s43, 0
    s_add_u32 m0, m0, 1024
    s_nop 0
    global_load_lds_dwordx4 v5, s[42:43] nt
    s_add_u32 s42, s42, 20480
    s_addc_u32 s43, s43, 0
    s_add_u32 m0, m0, 1024
    s_nop 0
    global_load_lds_dwordx4 v5, s[42:43] nt
    s_add_u32 s42, s42, 20480
    s_addc_u32 s43, s43, 0
    s_add_u32 m0, m0, 1024
    s_nop 0
    global_load_lds_dwordx4 v5, s[42:43] nt
    s_add_u32 s42, s42, 20480
    s_addc_u32 s43, s43, 0
    s_add_u32 m0, m0, 1024
    s_nop 0
    global_load_lds_dwordx4 v5, s[42:43] nt
    s_add_u32 s42, s42, 20480
    s_addc_u32 s43, s43, 0
    s_add_u32 m0, m0, 1024
    s_nop 0
    global_load_lds_dwordx4 v5, s[42:43] nt
    s_add_u32 s42, s42, 20480
    s_addc_u32 s43, s43, 0
    s_add_u32 m0, m0, 1024
    s_nop 0
    global_load_lds_dwordx4 v5, s[42:43] nt
    s_add_u32 s42, s42, 20480
    s_addc_u32 s43, s43, 0
    s_add_u32 m0, m0, 1024
    s_nop 0
    global_load_lds_dwordx4 v5, s[42:43] nt
    s_add_u32 s42, s42, 20480
    s_addc_u32 s43, s43, 0
    s_add_u32 m0, m0, 1024
    s_nop 0
    global_load_lds_dwordx4 v5, s[42:43] nt
    s_add_u32 s42, s42, 20480
    s_addc_u32 s43, s43, 0
    s_add_u32 m0, m0, 1024
    s_nop 0
    global_load_lds_dwordx4 v5, s[42:43] nt
    s_add_u32 s42, s42, 20480
    s_addc_u32 s43, s43, 0
    s_add_u32 m0, m0, 1024
    s_nop 0
    global_load_lds_dwordx4 v5, s[42:43] nt
    s_add_u32 s42, s42, 20480
    s_addc_u32 s43, s43, 0
    s_add_u32 m0, m0, 1024
    s_nop 0
    global_load_lds_dwordx4 v5, s[42:43] nt
    s_waitcnt vmcnt(0)
    s_mov_b64 s[100:101], exec
    s_mov_b64 exec, 1
    ds_add_u32 v61, v62 offset:40
    s_mov_b64 exec, s[100:101]
    s_branch L_fin
L_T7_l:
    s_cmp_ge_u32 s54, 20
    s_cbranch_scc1 L_fin
    v_lshrrev_b32 v3, 2, v0
    v_and_b32 v4, 3, v0
    v_bfe_u32 v5, v0, 4, 1
    v_lshlrev_b32 v5, 1, v5
    v_xor_b32 v4, v4, v5
    v_lshlrev_b32 v4, 4, v4
    s_mov_b32 s47, 1280
    v_mul_lo_u32 v5, v3, s47
    v_add_u32 v5, v5, v4
    s_lshl_b32 s46, s54, 6
    s_mul_i32 s44, s40, 552960
    s_add_u32 s46, s46, s44
    s_mul_i32 s47, s40, 27648
    s_add_u32 s42, s22, s46
    s_addc_u32 s43, s23, 0
    s_add_u32 m0, s47, 0
    s_nop 0
    global_load_lds_dwordx4 v5, s[42:43] nt
    s_add_u32 s42, s42, 20480
    s_addc_u32 s43, s43, 0
    s_add_u32 m0, m0, 1024
    s_nop 0
    global_load_lds_dwordx4 v5, s[42:43] nt
    s_add_u32 s42, s42, 20480
    s_addc_u32 s43, s43, 0
    s_add_u32 m0, m0, 1024
    s_nop 0
    global_load_lds_dwordx4 v5, s[42:43] nt
    s_add_u32 s42, s42, 20480
    s_addc_u32 s43, s43, 0
    s_add_u32 m0, m0, 1024
    s_nop 0
    global_load_lds_dwordx4 v5, s[42:43] nt
    s_add_u32 s42, s42, 20480
    s_addc_u32 s43, s43, 0
    s_add_u32 m0, m0, 1024
    s_nop 0
    global_load_lds_dwordx4 v5, s[42:43] nt
    s_add_u32 s42, s42, 20480
    s_addc_u32 s43, s43, 0
    s_add_u32 m0, m0, 1024
    s_nop 0
    global_load_lds_dwordx4 v5, s[42:43] nt
    s_add_u32 s42, s42, 20480
    s_addc_u32 s43, s43, 0
    s_add_u32 m0, m0, 1024
    s_nop 0
    global_load_lds_dwordx4 v5, s[42:43] nt
    s_add_u32 s42, s42, 20480
    s_addc_u32 s43, s43, 0
    s_add_u32 m0, m0, 1024
    s_nop 0
    global_load_lds_dwordx4 v5, s[42:43] nt
    s_add_u32 s42, s42, 20480
    s_addc_u32 s43, s43, 0
    s_add_u32 m0, m0, 1024
    s_nop 0
    global_load_lds_dwordx4 v5, s[42:43] nt
    s_add_u32 s42, s42, 20480
    s_addc_u32 s43, s43, 0
    s_add_u32 m0, m0, 1024
    s_nop 0
    global_load_lds_dwordx4 v5, s[42:43] nt
    s_add_u32 s42, s42, 20480
    s_addc_u32 s43, s43, 0
    s_add_u32 m0, m0, 1024
    s_nop 0
    global_load_lds_dwordx4 v5, s[42:43] nt
    s_add_u32 s42, s42, 20480
    s_addc_u32 s43, s43, 0
    s_add_u32 m0, m0, 1024
    s_nop 0
    global_load_lds_dwordx4 v5, s[42:43] nt
    s_add_u32 s42, s42, 20480
    s_addc_u32 s43, s43, 0
    s_add_u32 m0, m0, 1024
    s_nop 0
    global_load_lds_dwordx4 v5, s[42:43] nt
    s_add_u32 s42, s42, 20480
    s_addc_u32 s43, s43, 0
    s_add_u32 m0, m0, 1024
    s_nop 0
    global_load_lds_dwordx4 v5, s[42:43] nt
    s_add_u32 s42, s42, 20480
    s_addc_u32 s43, s43, 0
    s_add_u32 m0, m0, 1024
    s_nop 0
    global_load_lds_dwordx4 v5, s[42:43] nt
    s_add_u32 s42, s42, 20480
    s_addc_u32 s43, s43, 0
    s_add_u32 m0, m0, 1024
    s_nop 0
    global_load_lds_dwordx4 v5, s[42:43] nt
    s_add_u32 s42, s42, 20480
    s_addc_u32 s43, s43, 0
    s_add_u32 m0, m0, 1024
    s_nop 0
    global_load_lds_dwordx4 v5, s[42:43] nt
    s_add_u32 s42, s42, 20480
    s_addc_u32 s43, s43, 0
    s_add_u32 m0, m0, 1024
    s_nop 0
    global_load_lds_dwordx4 v5, s[42:43] nt
    s_add_u32 s42, s42, 20480
    s_addc_u32 s43, s43, 0
    s_add_u32 m0, m0, 1024
    s_nop 0
    global_load_lds_dwordx4 v5, s[42:43] nt
    s_add_u32 s42, s42, 20480
    s_addc_u32 s43, s43, 0
    s_add_u32 m0, m0, 1024
    s_nop 0
    global_load_lds_dwordx4 v5, s[42:43] nt
    s_add_u32 s42, s42, 20480
    s_addc_u32 s43, s43, 0
    s_add_u32 m0, m0, 1024
    s_nop 0
    global_load_lds_dwordx4 v5, s[42:43] nt
    s_add_u32 s42, s42, 20480
    s_addc_u32 s43, s43, 0
    s_add_u32 m0, m0, 1024
    s_nop 0
    global_load_lds_dwordx4 v5, s[42:43] nt
    s_add_u32 s42, s42, 20480
    s_addc_u32 s43, s43, 0
    s_add_u32 m0, m0, 1024
    s_nop 0
    global_load_lds_dwordx4 v5, s[42:43] nt
    s_add_u32 s42, s42, 20480
    s_addc_u32 s43, s43, 0
    s_add_u32 m0, m0, 1024
    s_nop 0
    global_load_lds_dwordx4 v5, s[42:43] nt
    s_add_u32 s42, s42, 20480
    s_addc_u32 s43, s43, 0
    s_add_u32 m0, m0, 1024
    s_nop 0
    global_load_lds_dwordx4 v5, s[42:43] nt
    s_add_u32 s42, s42, 20480
    s_addc_u32 s43, s43, 0
    s_add_u32 m0, m0, 1024
    s_nop 0
    global_load_lds_dwordx4 v5, s[42:43] nt
    s_add_u32 s42, s42, 20480
    s_addc_u32 s43, s43, 0
    s_add_u32 m0, m0, 1024
    s_nop 0
    global_load_lds_dwordx4 v5, s[42:43] nt
    s_waitcnt vmcnt(0)
    s_mov_b64 s[100:101], exec
    s_mov_b64 exec, 1
    ds_add_u32 v61, v62 offset:40
    s_mov_b64 exec, s[100:101]
    s_branch L_fin
L_F_c:
    s_sub_u32 s41, s35, 16
    s_lshl_b32 s39, s34, 3
    s_add_u32 s39, s39, s41
    s_mul_i32 s51, s34, 5
    s_add_u32 s51, s51, s41
    s_sub_u32 s51, s51, 8
    s_cmp_lt_u32 s41, 8
    s_cbranch_scc1 L_Y_c
    s_cmp_ge_u32 s41, 13
    s_cbranch_scc1 L_tail_c
    s_mul_i32 s42, s3, 1280
    v_lshlrev_b32 v4, 2, v0
    v_add_u32 v4, s42, v4
    global_load_dword v10, v4, s[24:25] offset:0
    global_load_dword v11, v4, s[24:25] offset:256
    global_load_dword v12, v4, s[24:25] offset:512
    global_load_dword v13, v4, s[24:25] offset:768
    global_load_dword v14, v4, s[24:25] offset:1024
    v_lshlrev_b32 v6, 6, v2
    v_bfe_u32 v7, v0, 1, 2
    v_lshlrev_b32 v7, 4, v7
    v_bfe_u32 v8, v0, 3, 1
    v_lshlrev_b32 v8, 3, v8
    v_and_b32 v9, 1, v0
    v_lshlrev_b32 v9, 2, v9
    v_add3_u32 v6, v6, v7, v8
    s_mul_i32 s42, s3, 1344
    s_add_u32 s42, s42, 151552
    v_add3_u32 v6, v6, v9, s42
    s_mov_b32 s43, 0xbfb8aa3b
    s_waitcnt vmcnt(0)
    v_lshlrev_b32 v20, 16, v10
    v_and_b32 v21, 0xffff0000, v10
    v_mul_f32 v22, s43, v20
    v_mul_f32 v23, s43, v21
    v_exp_f32 v22, v22
    v_exp_f32 v23, v23
    s_nop 0
    v_add_f32 v22, 1.0, v22
    v_add_f32 v23, 1.0, v23
    v_rcp_f32 v22, v22
    v_rcp_f32 v23, v23
    s_nop 0
    v_mul_f32 v20, v20, v22
    v_mul_f32 v21, v21, v23
    v_cvt_pk_bf16_f32 v20, v20, v21
    ds_write_b32 v6, v20 offset:0
    v_lshlrev_b32 v20, 16, v11
    v_and_b32 v21, 0xffff0000, v11
    v_mul_f32 v22, s43, v20
    v_mul_f32 v23, s43, v21
    v_exp_f32 v22, v22
    v_exp_f32 v23, v23
    s_nop 0
    v_add_f32 v22, 1.0, v22
    v_add_f32 v23, 1.0, v23
    v_rcp_f32 v22, v22
    v_rcp_f32 v23, v23
    s_nop 0
    v_mul_f32 v20, v20, v22
    v_mul_f32 v21, v21, v23
    v_cvt_pk_bf16_f32 v20, v20, v21
    ds_write_b32 v6, v20 offset:256
    v_lshlrev_b32 v20, 16, v12
    v_and_b32 v21, 0xffff0000, v12
    v_mul_f32 v22, s43, v20
    v_mul_f32 v23, s43, v21
    v_exp_f32 v22, v22
    v_exp_f32 v23, v23
    s_nop 0
    v_add_f32 v22, 1.0, v22
    v_add_f32 v23, 1.0, v23
    v_rcp_f32 v22, v22
    v_rcp_f32 v23, v23
    s_nop 0
    v_mul_f32 v20, v20, v22
    v_mul_f32 v21, v21, v23
    v_cvt_pk_bf16_f32 v20, v20, v21
    ds_write_b32 v6, v20 offset:512
    v_lshlrev_b32 v20, 16, v13
    v_and_b32 v21, 0xffff0000, v13
    v_mul_f32 v22, s43, v20
    v_mul_f32 v23, s43, v21
    v_exp_f32 v22, v22
    v_exp_f32 v23, v23
    s_nop 0
    v_add_f32 v22, 1.0, v22
    v_add_f32 v23, 1.0, v23
    v_rcp_f32 v22, v22
    v_rcp_f32 v23, v23
    s_nop 0
    v_mul_f32 v20, v20, v22
    v_mul_f32 v21, v21, v23
    v_cvt_pk_bf16_f32 v20, v20, v21
    ds_write_b32 v6, v20 offset:768
    v_lshlrev_b32 v20, 16, v14
    v_and_b32 v21, 0xffff0000, v14
    v_mul_f32 v22, s43, v20
    v_mul_f32 v23, s43, v21
    v_exp_f32 v22, v22
    v_exp_f32 v23, v23
    s_nop 0
    v_add_f32 v22, 1.0, v22
    v_add_f32 v23, 1.0, v23
    v_rcp_f32 v22, v22
    v_rcp_f32 v23, v23
    s_nop 0
    v_mul_f32 v20, v20, v22
    v_mul_f32 v21, v21, v23
    v_cvt_pk_bf16_f32 v20, v20, v21
    ds_write_b32 v6, v20 offset:1024
    s_mov_b64 s[100:101], exec
    s_mov_b64 exec, 1
    ds_add_u32 v61, v62 offset:0
    s_mov_b64 exec, s[100:101]
    s_and_b32 s42, s51, 1
    s_mul_i32 s42, s42, 640
    v_and_b32 v8, 3, v0
    v_mul_u32_u24 v8, 1344, v8
    v_lshlrev_b32 v9, 4, v2
    s_add_u32 s47, s42, 151552
    v_add3_u32 v8, v8, v9, s47
    v_lshrrev_b32 v9, 2, v1
    v_lshl_add_u32 v9, v2, 2, v9
    v_lshlrev_b32 v25, 7, v9
    v_bfe_u32 v9, v9, 1, 2
    v_lshlrev_b32 v9, 1, v9
    v_bfe_u32 v24, v1, 1, 1
    v_xor_b32 v9, v9, v24
    s_lshl_b32 s47, s3, 1
    v_xor_b32 v9, s47, v9
    v_lshl_add_u32 v25, v9, 4, v25
    v_and_b32 v9, 1, v1
    v_lshl_add_u32 v25, v9, 3, v25
    s_lshr_b32 s42, s51, 1
    s_lshl_b32 s42, s42, 2
    s_add_u32 s42, s42, s3
    s_lshl_b32 s42, s42, 8
    s_and_b32 s43, s51, 1
    s_mul_i32 s43, s43, 65536
    s_add_u32 s42, s42, s43
    s_add_u32 s42, s42, 4096
    v_lshl_add_u32 v21, v1, 4, s42
    s_waitcnt lgkmcnt(0)
    s_add_u32 s36, s38, 1
    s_not_b32 s37, s36
L_lw_21:
    ds_read_b32 v63, v61 offset:0
    s_waitcnt lgkmcnt(0)
    v_readfirstlane_b32 s59, v63
    s_cmp_lt_u32 s59, 8
    s_cbranch_scc1 L_lw_21
    ds_read_b128 v[64:67], v8 offset:0
    ds_read_b64_tr_b16 v[68:69], v25 offset:0
    ds_read_b64_tr_b16 v[70:71], v25 offset:2048
    ds_read_b128 v[72:75], v8 offset:64
    ds_read_b64_tr_b16 v[76:77], v25 offset:4096
    ds_read_b64_tr_b16 v[78:79], v25 offset:6144
    ds_read_b128 v[80:83], v8 offset:128
    ds_read_b64_tr_b16 v[84:85], v25 offset:8192
    ds_read_b64_tr_b16 v[86:87], v25 offset:10240
    ds_read_b128 v[88:91], v8 offset:192
    ds_read_b64_tr_b16 v[92:93], v25 offset:12288
    ds_read_b64_tr_b16 v[94:95], v25 offset:14336
    ds_read_b128 v[96:99], v8 offset:256
    ds_read_b64_tr_b16 v[100:101], v25 offset:16384
    ds_read_b64_tr_b16 v[102:103], v25 offset:18432
    ds_read_b128 v[104:107], v8 offset:320
    ds_read_b64_tr_b16 v[108:109], v25 offset:20480
    ds_read_b64_tr_b16 v[110:111], v25 offset:22528
    ds_read_b128 v[112:115], v8 offset:384
    ds_read_b64_tr_b16 v[116:117], v25 offset:24576
    ds_read_b64_tr_b16 v[118:119], v25 offset:26624
    ds_read_b128 v[120:123], v8 offset:448
    ds_read_b64_tr_b16 v[124:125], v25 offset:28672
    ds_read_b64_tr_b16 v[126:127], v25 offset:30720
    ds_read_b128 v[128:131], v8 offset:512
    ds_read_b64_tr_b16 v[132:133], v25 offset:32768
    ds_read_b64_tr_b16 v[134:135], v25 offset:34816
    ds_read_b128 v[136:139], v8 offset:576
    ds_read_b64_tr_b16 v[140:141], v25 offset:36864
    ds_read_b64_tr_b16 v[142:143], v25 offset:38912
    s_waitcnt lgkmcnt(15)
    v_mfma_f32_16x16x32_bf16 v[28:31], v[64:67], v[68:71], 0
    s_waitcnt lgkmcnt(15)
    v_mfma_f32_16x16x32_bf16 v[28:31], v[72:75], v[76:79], v[28:31]
    s_waitcnt lgkmcnt(15)
    v_mfma_f32_16x16x32_bf16 v[28:31], v[80:83], v[84:87], v[28:31]
    s_waitcnt lgkmcnt(15)
    v_mfma_f32_16x16x32_bf16 v[28:31], v[88:91], v[92:95], v[28:31]
    s_waitcnt lgkmcnt(15)
    v_mfma_f32_16x16x32_bf16 v[28:31], v[96:99], v[100:103], v[28:31]
    s_waitcnt lgkmcnt(12)
    v_mfma_f32_16x16x32_bf16 v[28:31], v[104:107], v[108:111], v[28:31]
    s_waitcnt lgkmcnt(9)
    v_mfma_f32_16x16x32_bf16 v[28:31], v[112:115], v[116:119], v[28:31]
    s_waitcnt lgkmcnt(6)
    v_mfma_f32_16x16x32_bf16 v[28:31], v[120:123], v[124:127], v[28:31]
    s_waitcnt lgkmcnt(3)
    v_mfma_f32_16x16x32_bf16 v[28:31], v[128:131], v[132:135], v[28:31]
    s_waitcnt lgkmcnt(0)
    v_mfma_f32_16x16x32_bf16 v[28:31], v[136:139], v[140:143], v[28:31]
    s_mov_b64 s[100:101], exec
    s_mov_b64 exec, 1
    ds_add_u32 v61, v62 offset:20
    s_mov_b64 exec, s[100:101]
    s_nop 7
    s_mov_b64 s[48:49], exec
    s_mov_b64 exec, 0xffff
    v_cvt_pk_bf16_f32 v64, v28, v29
    v_cvt_pk_bf16_f32 v65, v30, v31
    v_mov_b32 v66, s36
    v_mov_b32 v67, s37
    global_store_dwordx4 v21, v[64:67], s[32:33] sc1
    s_mov_b64 exec, s[48:49]
    s_branch L_tail_c
L_Y_c:
    s_mul_i32 s42, s3, 1280
    v_lshlrev_b32 v4, 2, v0
    v_add_u32 v4, s42, v4
    global_load_dword v15, v4, s[4:5] offset:0
    global_load_dword v16, v4, s[4:5] offset:256
    global_load_dword v17, v4, s[4:5] offset:512
    global_load_dword v18, v4, s[4:5] offset:768
    global_load_dword v19, v4, s[4:5] offset:1024
    v_lshlrev_b32 v6, 6, v2
    v_bfe_u32 v7, v0, 1, 2
    v_lshlrev_b32 v7, 4, v7
    v_bfe_u32 v8, v0, 3, 1
    v_lshlrev_b32 v8, 3, v8
    v_and_b32 v9, 1, v0
    v_lshlrev_b32 v9, 2, v9
    v_add3_u32 v6, v6, v7, v8
    s_mul_i32 s42, s3, 1344
    s_add_u32 s42, s42, 151552
    v_add3_u32 v6, v6, v9, s42
    s_mov_b32 s43, 0xbfb8aa3b
    s_waitcnt vmcnt(0)
    v_lshlrev_b32 v40, 16, v15
    v_and_b32 v41, 0xffff0000, v15
    v_lshlrev_b32 v42, 16, v16
    v_and_b32 v43, 0xffff0000, v16
    v_lshlrev_b32 v44, 16, v17
    v_and_b32 v45, 0xffff0000, v17
    v_lshlrev_b32 v46, 16, v18
    v_and_b32 v47, 0xffff0000, v18
    v_lshlrev_b32 v48, 16, v19
    v_and_b32 v49, 0xffff0000, v19
    v_add_f32 v20, v40, v41
    v_mul_f32 v21, v40, v40
    v_fmac_f32 v21, v41, v41
    v_add_f32 v20, v20, v42
    v_fmac_f32 v21, v42, v42
    v_add_f32 v20, v20, v43
    v_fmac_f32 v21, v43, v43
    v_add_f32 v20, v20, v44
    v_fmac_f32 v21, v44, v44
    v_add_f32 v20, v20, v45
    v_fmac_f32 v21, v45, v45
    v_add_f32 v20, v20, v46
    v_fmac_f32 v21, v46, v46
    v_add_f32 v20, v20, v47
    v_fmac_f32 v21, v47, v47
    v_add_f32 v20, v20, v48
    v_fmac_f32 v21, v48, v48
    v_add_f32 v20, v20, v49
    v_fmac_f32 v21, v49, v49
    s_nop 1
    v_add_f32_dpp v20, v20, v20 quad_perm:[1,0,3,2] row_mask:0xf bank_mask:0xf
    s_nop 1
    v_add_f32_dpp v20, v20, v20 quad_perm:[2,3,0,1] row_mask:0xf bank_mask:0xf
    s_nop 1
    v_add_f32_dpp v20, v20, v20 row_half_mirror row_mask:0xf bank_mask:0xf
    s_nop 1
    v_add_f32_dpp v20, v20, v20 row_mirror row_mask:0xf bank_mask:0xf
    s_nop 0
    v_mov_b32 v18, v20
    s_nop 1
    v_permlane16_swap_b32 v20, v18
    s_nop 1
    v_add_f32 v20, v20, v18
    v_mov_b32 v18, v20
    s_nop 1
    v_permlane32_swap_b32 v20, v18
    s_nop 1
    v_add_f32 v20, v20, v18
    s_nop 1
    v_add_f32_dpp v21, v21, v21 quad_perm:[1,0,3,2] row_mask:0xf bank_mask:0xf
    s_nop 1
    v_add_f32_dpp v21, v21, v21 quad_perm:[2,3,0,1] row_mask:0xf bank_mask:0xf
    s_nop 1
    v_add_f32_dpp v21, v21, v21 row_half_mirror row_mask:0xf bank_mask:0xf
    s_nop 1
    v_add_f32_dpp v21, v21, v21 row_mirror row_mask:0xf bank_mask:0xf
    s_nop 0
    v_mov_b32 v18, v21
    s_nop 1
    v_permlane16_swap_b32 v21, v18
    s_nop 1
    v_add_f32 v21, v21, v18
    v_mov_b32 v18, v21
    s_nop 1
    v_permlane32_swap_b32 v21, v18
    s_nop 1
    v_add_f32 v21, v21, v18
    s_mov_b32 s43, 0x3acccccd
    v_mul_f32 v20, s43, v20
    v_mul_f32 v21, s43, v21
    v_fma_f32 v21, -v20, v20, v21
    v_add_f32 v21, 0x3727c5ac, v21
    v_rsq_f32 v21, v21
    s_lshl_b32 s42, s3, 1
    s_add_u32 s42, s42, 156928
    v_lshlrev_b32 v7, 4, v0
    v_add_u32 v7, s42, v7
    v_sub_f32 v18, v40, v20
    v_sub_f32 v19, v41, v20
    v_mul_f32 v18, v18, v21
    v_mul_f32 v19, v19, v21
    v_cvt_pk_bf16_f32 v18, v18, v19
    ds_write_b16 v7, v18 offset:0
    ds_write_b16_d16_hi v7, v18 offset:8
    v_sub_f32 v18, v42, v20
    v_sub_f32 v19, v43, v20
    v_mul_f32 v18, v18, v21
    v_mul_f32 v19, v19, v21
    v_cvt_pk_bf16_f32 v18, v18, v19
    ds_write_b16 v7, v18 offset:1024
    ds_write_b16_d16_hi v7, v18 offset:1032
    v_sub_f32 v18, v44, v20
    v_sub_f32 v19, v45, v20
    v_mul_f32 v18, v18, v21
    v_mul_f32 v19, v19, v21
    v_cvt_pk_bf16_f32 v18, v18, v19
    ds_write_b16 v7, v18 offset:2048
    ds_write_b16_d16_hi v7, v18 offset:2056
    v_sub_f32 v18, v46, v20
    v_sub_f32 v19, v47, v20
    v_mul_f32 v18, v18, v21
    v_mul_f32 v19, v19, v21
    v_cvt_pk_bf16_f32 v18, v18, v19
    ds_write_b16 v7, v18 offset:3072
    ds_write_b16_d16_hi v7, v18 offset:3080
    v_sub_f32 v18, v48, v20
    v_sub_f32 v19, v49, v20
    v_mul_f32 v18, v18, v21
    v_mul_f32 v19, v19, v21
    v_cvt_pk_bf16_f32 v18, v18, v19
    ds_write_b16 v7, v18 offset:4096
    ds_write_b16_d16_hi v7, v18 offset:4104
    s_mov_b64 s[100:101], exec
    s_mov_b64 exec, 1
    ds_add_u32 v61, v62 offset:60
    s_mov_b64 exec, s[100:101]
    s_and_b32 s55, s39, 1
    s_mul_i32 s42, s55, 320
    v_add_u32 v5, 256, v3
    v_min_u32 v5, 319, v5
    v_add_u32 v4, s42, v3
    v_add_u32 v6, s42, v5
    v_lshlrev_b32 v7, 4, v4
    v_add_u32 v7, 4096, v7
    v_lshlrev_b32 v10, 4, v6
    v_add_u32 v10, 4096, v10
    v_add_u32 v11, 10240, v7
    v_add_u32 v12, 10240, v10
    v_add_u32 v26, 65536, v7
    v_add_u32 v27, 65536, v10
    v_add_u32 v28, 65536, v11
    v_add_u32 v29, 65536, v12
L_lw_24:
    ds_read_b32 v63, v61 offset:60
    s_waitcnt lgkmcnt(0)
    v_readfirstlane_b32 s59, v63
    s_cmp_lt_u32 s59, 4
    s_cbranch_scc1 L_lw_24
    v_lshlrev_b32 v13, 3, v4
    v_add_u32 v13, 156928, v13
    ds_read_b64 v[14:15], v13
    v_lshlrev_b32 v13, 3, v6
    v_add_u32 v13, 156928, v13
    ds_read_b64 v[16:17], v13
    v_and_b32 v20, 0xffffffe0, v3
    v_lshlrev_b32 v20, 1, v20
    v_bfe_u32 v56, v3, 2, 2
    v_lshlrev_b32 v56, 4, v56
    v_bfe_u32 v57, v3, 4, 1
    v_lshlrev_b32 v57, 3, v57
    v_add3_u32 v20, v20, v56, v57
    v_and_b32 v56, 3, v3
    v_lshlrev_b32 v56, 1, v56
    v_add_u32 v20, v20, v56
    v_add_u32 v20, 151552, v20
    v_and_b32 v21, 0xffffffe0, v5
    v_lshlrev_b32 v21, 1, v21
    v_bfe_u32 v56, v5, 2, 2
    v_lshlrev_b32 v56, 4, v56
    v_bfe_u32 v57, v5, 4, 1
    v_lshlrev_b32 v57, 3, v57
    v_add3_u32 v21, v21, v56, v57
    v_and_b32 v56, 3, v5
    v_lshlrev_b32 v56, 1, v56
    v_add_u32 v21, v21, v56
    v_add_u32 v21, 151552, v21
    s_waitcnt lgkmcnt(0)
    v_lshlrev_b32 v40, 16, v14
    v_and_b32 v41, 0xffff0000, v14
    v_lshlrev_b32 v42, 16, v15
    v_and_b32 v43, 0xffff0000, v15
    v_lshlrev_b32 v44, 16, v16
    v_and_b32 v45, 0xffff0000, v16
    v_lshlrev_b32 v46, 16, v17
    v_and_b32 v47, 0xffff0000, v17
    s_mov_b32 s42, 0
    v_and_b32 v8, 3, v0
    v_mul_u32_u24 v8, 1344, v8
    v_lshlrev_b32 v9, 4, v2
    s_add_u32 s47, s42, 151552
    v_add3_u32 v8, v8, v9, s47
    v_lshrrev_b32 v24, 2, v1
    v_lshl_add_u32 v24, v2, 2, v24
    v_and_b32 v25, 7, v24
    v_lshlrev_b32 v25, 1, v25
    v_bfe_u32 v9, v1, 1, 1
    v_xor_b32 v25, v25, v9
    v_lshlrev_b32 v25, 4, v25
    v_and_b32 v9, 1, v1
    v_lshlrev_b32 v9, 3, v9
    v_lshlrev_b32 v24, 8, v24
    v_add3_u32 v24, v24, v25, v9
    s_lshl_b32 s42, s3, 6
    v_xor_b32 v24, s42, v24
    v_xor_b32 v25, 32, v24
    s_lshr_b32 s42, s39, 1
    s_lshl_b32 s42, s42, 3
    s_lshl_b32 s43, s3, 1
    s_add_u32 s42, s42, s43
    s_lshl_b32 s42, s42, 8
    s_lshl_b32 s43, s55, 16
    s_add_u32 s42, s42, s43
    s_add_u32 s42, s42, 131072
    v_lshrrev_b32 v13, 2, v1
    v_lshlrev_b32 v13, 8, v13
    v_and_b32 v14, 3, v1
    v_lshl_add_u32 v13, v14, 6, v13
    v_lshl_add_u32 v13, v2, 4, v13
    v_add_u32 v13, s42, v13
    s_mov_b32 s52, 0x00ff00ff
    s_mov_b32 s53, 0x00ff00ff
    s_waitcnt lgkmcnt(0)
    s_add_u32 s36, s38, 1
    s_not_b32 s37, s36
L_lw_25:
    s_sleep 1
    ds_read_b32 v63, v61 offset:8
    s_waitcnt lgkmcnt(0)
    v_readfirstlane_b32 s59, v63
    s_cmp_lt_u32 s59, 4
    s_cbranch_scc1 L_lw_25
    v_add_u32 v56, 65536, v24
    ds_read_b64_tr_b16 v[144:145], v24 offset:0
    ds_read_b64_tr_b16 v[146:147], v24 offset:4096
    ds_read_b64_tr_b16 v[148:149], v24 offset:8192
    ds_read_b64_tr_b16 v[150:151], v24 offset:12288
    ds_read_b64_tr_b16 v[152:153], v24 offset:16384
    ds_read_b64_tr_b16 v[154:155], v24 offset:20480
    ds_read_b64_tr_b16 v[156:157], v24 offset:24576
    ds_read_b64_tr_b16 v[158:159], v24 offset:28672
    ds_read_b64_tr_b16 v[160:161], v24 offset:32768
    ds_read_b64_tr_b16 v[162:163], v24 offset:36864
    ds_read_b64_tr_b16 v[164:165], v24 offset:40960
    ds_read_b64_tr_b16 v[166:167], v24 offset:45056
    ds_read_b64_tr_b16 v[168:169], v24 offset:49152
    ds_read_b64_tr_b16 v[170:171], v24 offset:53248
    ds_read_b64_tr_b16 v[172:173], v24 offset:57344
    ds_read_b64_tr_b16 v[174:175], v24 offset:61440
    ds_read_b64_tr_b16 v[176:177], v56 offset:0
    ds_read_b64_tr_b16 v[178:179], v56 offset:4096
    ds_read_b64_tr_b16 v[180:181], v56 offset:8192
    ds_read_b64_tr_b16 v[182:183], v56 offset:12288
    s_waitcnt lgkmcnt(0)
    v_add_u32 v56, 65536, v25
    ds_read_b64_tr_b16 v[184:185], v25 offset:0
    ds_read_b64_tr_b16 v[186:187], v25 offset:4096
    ds_read_b64_tr_b16 v[188:189], v25 offset:8192
    ds_read_b64_tr_b16 v[190:191], v25 offset:12288
    ds_read_b64_tr_b16 v[192:193], v25 offset:16384
    ds_read_b64_tr_b16 v[194:195], v25 offset:20480
    ds_read_b64_tr_b16 v[196:197], v25 offset:24576
    ds_read_b64_tr_b16 v[198:199], v25 offset:28672
    ds_read_b64_tr_b16 v[200:201], v25 offset:32768
    ds_read_b64_tr_b16 v[202:203], v25 offset:36864
    ds_read_b64_tr_b16 v[204:205], v25 offset:40960
    ds_read_b64_tr_b16 v[206:207], v25 offset:45056
    ds_read_b64_tr_b16 v[208:209], v25 offset:49152
    ds_read_b64_tr_b16 v[210:211], v25 offset:53248
    ds_read_b64_tr_b16 v[212:213], v25 offset:57344
    ds_read_b64_tr_b16 v[214:215], v25 offset:61440
    ds_read_b64_tr_b16 v[216:217], v56 offset:0
    ds_read_b64_tr_b16 v[218:219], v56 offset:4096
    ds_read_b64_tr_b16 v[220:221], v56 offset:8192
    ds_read_b64_tr_b16 v[222:223], v56 offset:12288
    s_waitcnt lgkmcnt(0)
    s_mov_b32 s50, 0
L_poll_26:
    global_load_dwordx4 v[64:67], v7, s[32:33] sc1
    global_load_dwordx4 v[68:71], v10, s[32:33] sc1
    global_load_dwordx4 v[72:75], v11, s[32:33] sc1
    global_load_dwordx4 v[76:79], v12, s[32:33] sc1
    global_load_dwordx4 v[80:83], v26, s[32:33] sc1
    global_load_dwordx4 v[84:87], v27, s[32:33] sc1
    global_load_dwordx4 v[88:91], v28, s[32:33] sc1
    global_load_dwordx4 v[92:95], v29, s[32:33] sc1
    s_add_u32 s50, s50, 1
    s_waitcnt vmcnt(0)
    v_xor_b32 v58, s36, v66
    v_xor_b32 v59, s37, v67
    v_xor_b32 v57, s36, v70
    v_xor_b32 v56, s37, v71
    v_or3_b32 v58, v58, v57, v56
    v_xor_b32 v57, s36, v74
    v_xor_b32 v56, s37, v75
    v_or3_b32 v58, v58, v57, v56
    v_xor_b32 v57, s36, v78
    v_xor_b32 v56, s37, v79
    v_or3_b32 v58, v58, v57, v56
    v_xor_b32 v57, s36, v82
    v_xor_b32 v56, s37, v83
    v_or3_b32 v58, v58, v57, v56
    v_xor_b32 v57, s36, v86
    v_xor_b32 v56, s37, v87
    v_or3_b32 v58, v58, v57, v56
    v_xor_b32 v57, s36, v90
    v_xor_b32 v56, s37, v91
    v_or3_b32 v58, v58, v57, v56
    v_xor_b32 v57, s36, v94
    v_xor_b32 v56, s37, v95
    v_or3_b32 v58, v58, v57, v56
    v_or_b32 v58, v58, v59
    v_cmp_ne_u32 vcc, 0, v58
    s_cmp_ge_u32 s50, 262144
    s_cbranch_scc1 L_polld_27
    s_cbranch_vccnz L_poll_26
L_polld_27:
    s_mov_b64 s[100:101], exec
    s_mov_b64 exec, 1
    ds_add_u32 v61, v62 offset:92
    s_mov_b64 exec, s[100:101]
    v_lshlrev_b32 v122, 16, v64
    v_and_b32 v123, 0xffff0000, v64
    v_lshlrev_b32 v124, 16, v72
    v_and_b32 v125, 0xffff0000, v72
    v_lshlrev_b32 v116, 16, v80
    v_and_b32 v117, 0xffff0000, v80
    v_lshlrev_b32 v118, 16, v88
    v_and_b32 v119, 0xffff0000, v88
    v_pk_add_f32 v[124:125], v[124:125], v[118:119]
    v_pk_add_f32 v[122:123], v[122:123], v[116:117]
    v_pk_fma_f32 v[120:121], v[40:41], v[124:125], v[40:41]
    v_pk_add_f32 v[120:121], v[120:121], v[122:123]
    v_cvt_pk_bf16_f32 v120, v120, v121
    ds_write_b16 v20, v120 offset:0
    ds_write_b16_d16_hi v20, v120 offset:1344
    v_lshlrev_b32 v122, 16, v65
    v_and_b32 v123, 0xffff0000, v65
    v_lshlrev_b32 v124, 16, v73
    v_and_b32 v125, 0xffff0000, v73
    v_lshlrev_b32 v116, 16, v81
    v_and_b32 v117, 0xffff0000, v81
    v_lshlrev_b32 v118, 16, v89
    v_and_b32 v119, 0xffff0000, v89
    v_pk_add_f32 v[124:125], v[124:125], v[118:119]
    v_pk_add_f32 v[122:123], v[122:123], v[116:117]
    v_pk_fma_f32 v[120:121], v[42:43], v[124:125], v[42:43]
    v_pk_add_f32 v[120:121], v[120:121], v[122:123]
    v_cvt_pk_bf16_f32 v120, v120, v121
    ds_write_b16 v20, v120 offset:2688
    ds_write_b16_d16_hi v20, v120 offset:4032
    v_lshlrev_b32 v122, 16, v68
    v_and_b32 v123, 0xffff0000, v68
    v_lshlrev_b32 v124, 16, v76
    v_and_b32 v125, 0xffff0000, v76
    v_lshlrev_b32 v116, 16, v84
    v_and_b32 v117, 0xffff0000, v84
    v_lshlrev_b32 v118, 16, v92
    v_and_b32 v119, 0xffff0000, v92
    v_pk_add_f32 v[124:125], v[124:125], v[118:119]
    v_pk_add_f32 v[122:123], v[122:123], v[116:117]
    v_pk_fma_f32 v[120:121], v[44:45], v[124:125], v[44:45]
    v_pk_add_f32 v[120:121], v[120:121], v[122:123]
    v_cvt_pk_bf16_f32 v120, v120, v121
    ds_write_b16 v21, v120 offset:0
    ds_write_b16_d16_hi v21, v120 offset:1344
    v_lshlrev_b32 v122, 16, v69
    v_and_b32 v123, 0xffff0000, v69
    v_lshlrev_b32 v124, 16, v77
    v_and_b32 v125, 0xffff0000, v77
    v_lshlrev_b32 v116, 16, v85
    v_and_b32 v117, 0xffff0000, v85
    v_lshlrev_b32 v118, 16, v93
    v_and_b32 v119, 0xffff0000, v93
    v_pk_add_f32 v[124:125], v[124:125], v[118:119]
    v_pk_add_f32 v[122:123], v[122:123], v[116:117]
    v_pk_fma_f32 v[120:121], v[46:47], v[124:125], v[46:47]
    v_pk_add_f32 v[120:121], v[120:121], v[122:123]
    v_cvt_pk_bf16_f32 v120, v120, v121
    ds_write_b16 v21, v120 offset:2688
    ds_write_b16_d16_hi v21, v120 offset:4032
    s_mov_b64 s[100:101], exec
    s_mov_b64 exec, 1
    ds_add_u32 v61, v62 offset:12
    s_mov_b64 exec, s[100:101]
L_lw_28:
    ds_read_b32 v63, v61 offset:12
    s_waitcnt lgkmcnt(0)
    v_readfirstlane_b32 s59, v63
    s_cmp_lt_u32 s59, 4
    s_cbranch_scc1 L_lw_28
    ds_read_b128 v[64:67], v8 offset:0
    ds_read_b128 v[68:71], v8 offset:64
    ds_read_b128 v[72:75], v8 offset:128
    ds_read_b128 v[76:79], v8 offset:192
    ds_read_b128 v[80:83], v8 offset:256
    ds_read_b128 v[84:87], v8 offset:320
    ds_read_b128 v[88:91], v8 offset:384
    ds_read_b128 v[92:95], v8 offset:448
    ds_read_b128 v[96:99], v8 offset:512
    ds_read_b128 v[100:103], v8 offset:576
    s_waitcnt lgkmcnt(9)
    v_mfma_f32_16x16x32_bf16 v[28:31], v[144:147], v[64:67], 0
    v_mfma_f32_16x16x32_bf16 v[32:35], v[184:187], v[64:67], 0
    s_waitcnt lgkmcnt(8)
    v_mfma_f32_16x16x32_bf16 v[28:31], v[148:151], v[68:71], v[28:31]
    v_mfma_f32_16x16x32_bf16 v[32:35], v[188:191], v[68:71], v[32:35]
    s_waitcnt lgkmcnt(7)
    v_mfma_f32_16x16x32_bf16 v[28:31], v[152:155], v[72:75], v[28:31]
    v_mfma_f32_16x16x32_bf16 v[32:35], v[192:195], v[72:75], v[32:35]
    s_waitcnt lgkmcnt(6)
    v_mfma_f32_16x16x32_bf16 v[28:31], v[156:159], v[76:79], v[28:31]
    v_mfma_f32_16x16x32_bf16 v[32:35], v[196:199], v[76:79], v[32:35]
    s_waitcnt lgkmcnt(5)
    v_mfma_f32_16x16x32_bf16 v[28:31], v[160:163], v[80:83], v[28:31]
    v_mfma_f32_16x16x32_bf16 v[32:35], v[200:203], v[80:83], v[32:35]
    s_waitcnt lgkmcnt(4)
    v_mfma_f32_16x16x32_bf16 v[28:31], v[164:167], v[84:87], v[28:31]
    v_mfma_f32_16x16x32_bf16 v[32:35], v[204:207], v[84:87], v[32:35]
    s_waitcnt lgkmcnt(3)
    v_mfma_f32_16x16x32_bf16 v[28:31], v[168:171], v[88:91], v[28:31]
    v_mfma_f32_16x16x32_bf16 v[32:35], v[208:211], v[88:91], v[32:35]
    s_waitcnt lgkmcnt(2)
    v_mfma_f32_16x16x32_bf16 v[28:31], v[172:175], v[92:95], v[28:31]
    v_mfma_f32_16x16x32_bf16 v[32:35], v[212:215], v[92:95], v[32:35]
    s_waitcnt lgkmcnt(1)
    v_mfma_f32_16x16x32_bf16 v[28:31], v[176:179], v[96:99], v[28:31]
    v_mfma_f32_16x16x32_bf16 v[32:35], v[216:219], v[96:99], v[32:35]
    s_waitcnt lgkmcnt(0)
    v_mfma_f32_16x16x32_bf16 v[28:31], v[180:183], v[100:103], v[28:31]
    v_mfma_f32_16x16x32_bf16 v[32:35], v[220:223], v[100:103], v[32:35]
    v_mov_b32 v66, s36
    v_mov_b32 v67, s37
    s_nop 5
    v_cvt_pk_bf16_f32 v64, v28, v29
    v_cvt_pk_bf16_f32 v65, v30, v31
    v_cvt_pk_bf16_f32 v68, v32, v33
    v_cvt_pk_bf16_f32 v69, v34, v35
    s_nop 1
    v_mov_b32_dpp v64, v68 row_shr:4 row_mask:0xf bank_mask:0x2
    v_mov_b32_dpp v65, v69 row_shr:4 row_mask:0xf bank_mask:0x2
    s_mov_b64 s[48:49], exec
    s_mov_b64 exec, s[52:53]
    global_store_dwordx4 v13, v[64:67], s[32:33] sc1
    s_mov_b64 exec, s[48:49]
    v_xor_b32 v30, v1, v2
    v_lshlrev_b32 v30, 4, v30
    v_lshl_add_u32 v30, v1, 8, v30
    s_lshl_b32 s43, s3, 14
    s_add_u32 s43, s43, 81920
    v_add_u32 v30, s43, v30
    v_xor_b32 v32, 0, v30
    v_xor_b32 v33, 64, v30
    v_xor_b32 v34, 128, v30
    v_xor_b32 v35, 192, v30
    s_lshr_b32 s55, s39, 1
    s_lshl_b32 s42, s55, 11
    s_add_u32 s42, s42, 131072
    v_and_b32 v4, 3, v0
    v_lshlrev_b32 v4, 6, v4
    v_lshrrev_b32 v5, 1, v2
    v_lshl_add_u32 v4, v5, 8, v4
    v_and_b32 v5, 1, v2
    v_lshl_add_u32 v4, v5, 5, v4
    v_add_u32 v4, s42, v4
    s_lshl_b32 s42, s55, 11
    s_and_b32 s43, s39, 1
    s_lshl_b32 s43, s43, 2
    s_add_u32 s43, s43, s3
    s_lshl_b32 s43, s43, 8
    s_add_u32 s42, s42, s43
    s_add_u32 s42, s42, 262144
    v_and_b32 v5, 3, v1
    v_lshlrev_b32 v5, 16, v5
    v_lshrrev_b32 v6, 2, v1
    v_lshl_add_u32 v5, v6, 6, v5
    v_lshl_add_u32 v5, v2, 4, v5
    v_add_u32 v5, s42, v5
    s_mov_b32 s43, 0x3e0293ee
    v_mov_b32 v74, s36
    v_mov_b32 v75, s37
L_lw_29:
    ds_read_b32 v63, v61 offset:16
    s_waitcnt lgkmcnt(0)
    v_readfirstlane_b32 s59, v63
    s_cmp_lt_u32 s59, 4
    s_cbranch_scc1 L_lw_29
    ds_read_b128 v[128:131], v32 offset:0
    ds_read_b128 v[132:135], v33 offset:0
    ds_read_b128 v[136:139], v34 offset:0
    ds_read_b128 v[140:143], v35 offset:0
    ds_read_b128 v[144:147], v32 offset:4096
    ds_read_b128 v[148:151], v33 offset:4096
    ds_read_b128 v[152:155], v34 offset:4096
    ds_read_b128 v[156:159], v35 offset:4096
    ds_read_b128 v[160:163], v32 offset:8192
    ds_read_b128 v[164:167], v33 offset:8192
    ds_read_b128 v[168:171], v34 offset:8192
    ds_read_b128 v[172:175], v35 offset:8192
    ds_read_b128 v[176:179], v32 offset:12288
    ds_read_b128 v[180:183], v33 offset:12288
    ds_read_b128 v[184:187], v34 offset:12288
    ds_read_b128 v[188:191], v35 offset:12288
    s_waitcnt lgkmcnt(0)
    s_mov_b64 s[100:101], exec
    s_mov_b64 exec, 1
    ds_add_u32 v61, v62 offset:20
    s_mov_b64 exec, s[100:101]
    v_add_u32 v6, 0x10000, v4
    s_mov_b32 s50, 0
L_poll_30:
    global_load_dwordx4 v[96:99], v4, s[32:33] offset:0 sc1
    global_load_dwordx4 v[100:103], v4, s[32:33] offset:16 sc1
    global_load_dwordx4 v[104:107], v4, s[32:33] offset:512 sc1
    global_load_dwordx4 v[108:111], v4, s[32:33] offset:528 sc1
    global_load_dwordx4 v[112:115], v4, s[32:33] offset:1024 sc1
    global_load_dwordx4 v[116:119], v4, s[32:33] offset:1040 sc1
    global_load_dwordx4 v[120:123], v4, s[32:33] offset:1536 sc1
    global_load_dwordx4 v[124:127], v4, s[32:33] offset:1552 sc1
    global_load_dwordx4 v[192:195], v6, s[32:33] offset:0 sc1
    global_load_dwordx4 v[196:199], v6, s[32:33] offset:16 sc1
    global_load_dwordx4 v[200:203], v6, s[32:33] offset:512 sc1
    global_load_dwordx4 v[204:207], v6, s[32:33] offset:528 sc1
    global_load_dwordx4 v[208:211], v6, s[32:33] offset:1024 sc1
    global_load_dwordx4 v[212:215], v6, s[32:33] offset:1040 sc1
    global_load_dwordx4 v[216:219], v6, s[32:33] offset:1536 sc1
    global_load_dwordx4 v[220:223], v6, s[32:33] offset:1552 sc1
    s_add_u32 s50, s50, 1
    s_waitcnt vmcnt(0)
    v_xor_b32 v58, s36, v98
    v_xor_b32 v59, s37, v99
    v_xor_b32 v57, s36, v102
    v_xor_b32 v56, s37, v103
    v_or3_b32 v58, v58, v57, v56
    v_xor_b32 v57, s36, v106
    v_xor_b32 v56, s37, v107
    v_or3_b32 v58, v58, v57, v56
    v_xor_b32 v57, s36, v110
    v_xor_b32 v56, s37, v111
    v_or3_b32 v58, v58, v57, v56
    v_xor_b32 v57, s36, v114
    v_xor_b32 v56, s37, v115
    v_or3_b32 v58, v58, v57, v56
    v_xor_b32 v57, s36, v118
    v_xor_b32 v56, s37, v119
    v_or3_b32 v58, v58, v57, v56
    v_xor_b32 v57, s36, v122
    v_xor_b32 v56, s37, v123
    v_or3_b32 v58, v58, v57, v56
    v_xor_b32 v57, s36, v126
    v_xor_b32 v56, s37, v127
    v_or3_b32 v58, v58, v57, v56
    v_xor_b32 v57, s36, v194
    v_xor_b32 v56, s37, v195
    v_or3_b32 v58, v58, v57, v56
    v_xor_b32 v57, s36, v198
    v_xor_b32 v56, s37, v199
    v_or3_b32 v58, v58, v57, v56
    v_xor_b32 v57, s36, v202
    v_xor_b32 v56, s37, v203
    v_or3_b32 v58, v58, v57, v56
    v_xor_b32 v57, s36, v206
    v_xor_b32 v56, s37, v207
    v_or3_b32 v58, v58, v57, v56
    v_xor_b32 v57, s36, v210
    v_xor_b32 v56, s37, v211
    v_or3_b32 v58, v58, v57, v56
    v_xor_b32 v57, s36, v214
    v_xor_b32 v56, s37, v215
    v_or3_b32 v58, v58, v57, v56
    v_xor_b32 v57, s36, v218
    v_xor_b32 v56, s37, v219
    v_or3_b32 v58, v58, v57, v56
    v_xor_b32 v57, s36, v222
    v_xor_b32 v56, s37, v223
    v_or3_b32 v58, v58, v57, v56
    v_or_b32 v58, v58, v59
    v_cmp_ne_u32 vcc, 0, v58
    s_cmp_ge_u32 s50, 262144
    s_cbranch_scc1 L_polld_31
    s_cbranch_vccnz L_poll_30
L_polld_31:
    v_mov_b32 v98, v100
    v_mov_b32 v99, v101
    v_mov_b32 v106, v108
    v_mov_b32 v107, v109
    v_mov_b32 v114, v116
    v_mov_b32 v115, v117
    v_mov_b32 v122, v124
    v_mov_b32 v123, v125
    v_mov_b32 v194, v196
    v_mov_b32 v195, v197
    v_mov_b32 v202, v204
    v_mov_b32 v203, v205
    v_mov_b32 v210, v212
    v_mov_b32 v211, v213
    v_mov_b32 v218, v220
    v_mov_b32 v219, v221
    s_nop 0
    v_mfma_f32_16x16x32_bf16 v[28:31], v[128:131], v[96:99], 0
    v_mfma_f32_16x16x32_bf16 v[32:35], v[144:147], v[96:99], 0
    v_mfma_f32_16x16x32_bf16 v[36:39], v[160:163], v[96:99], 0
    v_mfma_f32_16x16x32_bf16 v[40:43], v[176:179], v[96:99], 0
    v_mfma_f32_16x16x32_bf16 v[28:31], v[132:135], v[104:107], v[28:31]
    v_mfma_f32_16x16x32_bf16 v[32:35], v[148:151], v[104:107], v[32:35]
    v_mfma_f32_16x16x32_bf16 v[36:39], v[164:167], v[104:107], v[36:39]
    v_mfma_f32_16x16x32_bf16 v[40:43], v[180:183], v[104:107], v[40:43]
    v_mfma_f32_16x16x32_bf16 v[28:31], v[136:139], v[112:115], v[28:31]
    v_mfma_f32_16x16x32_bf16 v[32:35], v[152:155], v[112:115], v[32:35]
    v_mfma_f32_16x16x32_bf16 v[36:39], v[168:171], v[112:115], v[36:39]
    v_mfma_f32_16x16x32_bf16 v[40:43], v[184:187], v[112:115], v[40:43]
    v_mfma_f32_16x16x32_bf16 v[28:31], v[140:143], v[120:123], v[28:31]
    v_mfma_f32_16x16x32_bf16 v[32:35], v[156:159], v[120:123], v[32:35]
    v_mfma_f32_16x16x32_bf16 v[36:39], v[172:175], v[120:123], v[36:39]
    v_mfma_f32_16x16x32_bf16 v[40:43], v[188:191], v[120:123], v[40:43]
    v_mfma_f32_16x16x32_bf16 v[28:31], v[128:131], v[192:195], v[28:31]
    v_mfma_f32_16x16x32_bf16 v[32:35], v[144:147], v[192:195], v[32:35]
    v_mfma_f32_16x16x32_bf16 v[36:39], v[160:163], v[192:195], v[36:39]
    v_mfma_f32_16x16x32_bf16 v[40:43], v[176:179], v[192:195], v[40:43]
    v_mfma_f32_16x16x32_bf16 v[28:31], v[132:135], v[200:203], v[28:31]
    v_mfma_f32_16x16x32_bf16 v[32:35], v[148:151], v[200:203], v[32:35]
    v_mfma_f32_16x16x32_bf16 v[36:39], v[164:167], v[200:203], v[36:39]
    v_mfma_f32_16x16x32_bf16 v[40:43], v[180:183], v[200:203], v[40:43]
    v_mfma_f32_16x16x32_bf16 v[28:31], v[136:139], v[208:211], v[28:31]
    v_mfma_f32_16x16x32_bf16 v[32:35], v[152:155], v[208:211], v[32:35]
    v_mfma_f32_16x16x32_bf16 v[36:39], v[168:171], v[208:211], v[36:39]
    v_mfma_f32_16x16x32_bf16 v[40:43], v[184:187], v[208:211], v[40:43]
    v_mfma_f32_16x16x32_bf16 v[28:31], v[140:143], v[216:219], v[28:31]
    v_mfma_f32_16x16x32_bf16 v[32:35], v[156:159], v[216:219], v[32:35]
    v_mfma_f32_16x16x32_bf16 v[36:39], v[172:175], v[216:219], v[36:39]
    v_mfma_f32_16x16x32_bf16 v[40:43], v[188:191], v[216:219], v[40:43]
    s_nop 4
    v_mul_f32 v28, s43, v28
    v_mul_f32 v29, s43, v29
    v_mul_f32 v30, s43, v30
    v_mul_f32 v31, s43, v31
    v_cvt_pk_bf16_f32 v64, v28, v29
    v_cvt_pk_bf16_f32 v65, v30, v31
    v_mul_f32 v32, s43, v32
    v_mul_f32 v33, s43, v33
    v_mul_f32 v34, s43, v34
    v_mul_f32 v35, s43, v35
    v_cvt_pk_bf16_f32 v66, v32, v33
    v_cvt_pk_bf16_f32 v67, v34, v35
    v_mul_f32 v36, s43, v36
    v_mul_f32 v37, s43, v37
    v_mul_f32 v38, s43, v38
    v_mul_f32 v39, s43, v39
    v_cvt_pk_bf16_f32 v68, v36, v37
    v_cvt_pk_bf16_f32 v69, v38, v39
    v_mul_f32 v40, s43, v40
    v_mul_f32 v41, s43, v41
    v_mul_f32 v42, s43, v42
    v_mul_f32 v43, s43, v43
    v_cvt_pk_bf16_f32 v70, v40, v41
    v_cvt_pk_bf16_f32 v71, v42, v43
    v_mov_b32 v72, v64
    v_mov_b32 v73, v65
    s_nop 0
    v_mov_b32_dpp v72, v66 row_shr:4 row_mask:0xf bank_mask:0x2
    v_mov_b32_dpp v73, v67 row_shr:4 row_mask:0xf bank_mask:0x2
    v_mov_b32_dpp v72, v68 row_shr:8 row_mask:0xf bank_mask:0x4
    v_mov_b32_dpp v73, v69 row_shr:8 row_mask:0xf bank_mask:0x4
    v_mov_b32_dpp v72, v70 row_shr:12 row_mask:0xf bank_mask:0x8
    v_mov_b32_dpp v73, v71 row_shr:12 row_mask:0xf bank_mask:0x8
    global_store_dwordx4 v5, v[72:75], s[32:33] sc1
    s_mov_b64 s[100:101], exec
    s_mov_b64 exec, 1
    ds_add_u32 v61, v62 offset:88
    s_mov_b64 exec, s[100:101]
L_tail_c:
    s_mul_i32 s51, s34, 5
    s_add_u32 s51, s51, s41
    s_mul_i32 s54, s34, 7
    s_add_u32 s54, s54, s41
    s_cmp_lt_u32 s41, 7
    s_cbranch_scc1 L_T6_c
    s_cmp_lt_u32 s41, 8
    s_cbranch_scc1 L_fin
    s_sub_u32 s51, s51, 11
    s_mul_i32 s54, s34, 3
    s_add_u32 s54, s54, s41
    s_sub_u32 s54, s54, 8
    s_cmp_lt_u32 s41, 11
    s_cbranch_scc1 L_T7_c
    s_branch L_T5_c
L_T6_c:
    s_cmp_ge_u32 s54, 54
    s_cbranch_scc1 L_fin
    s_cmp_ge_u32 s41, 5
    s_cbranch_scc1 L_B_no0n
L_lw_38:
    ds_read_b32 v63, v61 offset:20
    s_waitcnt lgkmcnt(0)
    v_readfirstlane_b32 s59, v63
    s_cmp_lt_u32 s59, 4
    s_cbranch_scc1 L_lw_38
    s_mul_i32 s42, s3, 1280
    v_lshlrev_b32 v4, 2, v0
    v_add_u32 v4, s42, v4
    global_load_dword v10, v4, s[24:25] offset:0
    global_load_dword v11, v4, s[24:25] offset:256
    global_load_dword v12, v4, s[24:25] offset:512
    global_load_dword v13, v4, s[24:25] offset:768
    global_load_dword v14, v4, s[24:25] offset:1024
    v_lshlrev_b32 v6, 6, v2
    v_bfe_u32 v7, v0, 1, 2
    v_lshlrev_b32 v7, 4, v7
    v_bfe_u32 v8, v0, 3, 1
    v_lshlrev_b32 v8, 3, v8
    v_and_b32 v9, 1, v0
    v_lshlrev_b32 v9, 2, v9
    v_add3_u32 v6, v6, v7, v8
    s_mul_i32 s42, s3, 1344
    s_add_u32 s42, s42, 151552
    v_add3_u32 v6, v6, v9, s42
    s_mov_b32 s43, 0xbfb8aa3b
    s_waitcnt vmcnt(0)
    v_lshlrev_b32 v20, 16, v10
    v_and_b32 v21, 0xffff0000, v10
    v_mul_f32 v22, s43, v20
    v_mul_f32 v23, s43, v21
    v_exp_f32 v22, v22
    v_exp_f32 v23, v23
    s_nop 0
    v_add_f32 v22, 1.0, v22
    v_add_f32 v23, 1.0, v23
    v_rcp_f32 v22, v22
    v_rcp_f32 v23, v23
    s_nop 0
    v_mul_f32 v20, v20, v22
    v_mul_f32 v21, v21, v23
    v_cvt_pk_bf16_f32 v20, v20, v21
    ds_write_b32 v6, v20 offset:0
    v_lshlrev_b32 v20, 16, v11
    v_and_b32 v21, 0xffff0000, v11
    v_mul_f32 v22, s43, v20
    v_mul_f32 v23, s43, v21
    v_exp_f32 v22, v22
    v_exp_f32 v23, v23
    s_nop 0
    v_add_f32 v22, 1.0, v22
    v_add_f32 v23, 1.0, v23
    v_rcp_f32 v22, v22
    v_rcp_f32 v23, v23
    s_nop 0
    v_mul_f32 v20, v20, v22
    v_mul_f32 v21, v21, v23
    v_cvt_pk_bf16_f32 v20, v20, v21
    ds_write_b32 v6, v20 offset:256
    v_lshlrev_b32 v20, 16, v12
    v_and_b32 v21, 0xffff0000, v12
    v_mul_f32 v22, s43, v20
    v_mul_f32 v23, s43, v21
    v_exp_f32 v22, v22
    v_exp_f32 v23, v23
    s_nop 0
    v_add_f32 v22, 1.0, v22
    v_add_f32 v23, 1.0, v23
    v_rcp_f32 v22, v22
    v_rcp_f32 v23, v23
    s_nop 0
    v_mul_f32 v20, v20, v22
    v_mul_f32 v21, v21, v23
    v_cvt_pk_bf16_f32 v20, v20, v21
    ds_write_b32 v6, v20 offset:512
    v_lshlrev_b32 v20, 16, v13
    v_and_b32 v21, 0xffff0000, v13
    v_mul_f32 v22, s43, v20
    v_mul_f32 v23, s43, v21
    v_exp_f32 v22, v22
    v_exp_f32 v23, v23
    s_nop 0
    v_add_f32 v22, 1.0, v22
    v_add_f32 v23, 1.0, v23
    v_rcp_f32 v22, v22
    v_rcp_f32 v23, v23
    s_nop 0
    v_mul_f32 v20, v20, v22
    v_mul_f32 v21, v21, v23
    v_cvt_pk_bf16_f32 v20, v20, v21
    ds_write_b32 v6, v20 offset:768
    v_lshlrev_b32 v20, 16, v14
    v_and_b32 v21, 0xffff0000, v14
    v_mul_f32 v22, s43, v20
    v_mul_f32 v23, s43, v21
    v_exp_f32 v22, v22
    v_exp_f32 v23, v23
    s_nop 0
    v_add_f32 v22, 1.0, v22
    v_add_f32 v23, 1.0, v23
    v_rcp_f32 v22, v22
    v_rcp_f32 v23, v23
    s_nop 0
    v_mul_f32 v20, v20, v22
    v_mul_f32 v21, v21, v23
    v_cvt_pk_bf16_f32 v20, v20, v21
    ds_write_b32 v6, v20 offset:1024
    s_mov_b64 s[100:101], exec
    s_mov_b64 exec, 1
    ds_add_u32 v61, v62 offset:72
    s_mov_b64 exec, s[100:101]
    s_mov_b32 s42, 0
    v_and_b32 v8, 3, v0
    v_mul_u32_u24 v8, 1344, v8
    v_lshlrev_b32 v9, 4, v2
    s_add_u32 s47, s42, 151552
    v_add3_u32 v8, v8, v9, s47
    v_lshrrev_b32 v9, 2, v1
    v_lshl_add_u32 v9, v2, 2, v9
    v_lshlrev_b32 v25, 7, v9
    v_bfe_u32 v9, v9, 1, 2
    v_lshlrev_b32 v9, 1, v9
    v_bfe_u32 v24, v1, 1, 1
    v_xor_b32 v9, v9, v24
    s_lshl_b32 s47, s3, 1
    v_xor_b32 v9, s47, v9
    v_lshl_add_u32 v25, v9, 4, v25
    v_and_b32 v9, 1, v1
    v_lshl_add_u32 v25, v9, 3, v25
    s_lshl_b32 s42, s51, 2
    s_add_u32 s42, s42, s3
    s_lshl_b32 s42, s42, 8
    s_add_u32 s42, s42, 24576
    v_lshl_add_u32 v21, v1, 4, s42
    s_waitcnt lgkmcnt(0)
    s_add_u32 s36, s38, 1
    s_not_b32 s37, s36
L_lw_39:
    ds_read_b32 v63, v61 offset:72
    s_waitcnt lgkmcnt(0)
    v_readfirstlane_b32 s59, v63
    s_cmp_lt_u32 s59, 8
    s_cbranch_scc1 L_lw_39
    v_add_u32 v56, 65536, v25
    ds_read_b128 v[64:67], v8 offset:0
    ds_read_b64_tr_b16 v[68:69], v25 offset:0
    ds_read_b64_tr_b16 v[70:71], v25 offset:2048
    ds_read_b128 v[72:75], v8 offset:64
    ds_read_b64_tr_b16 v[76:77], v25 offset:4096
    ds_read_b64_tr_b16 v[78:79], v25 offset:6144
    ds_read_b128 v[80:83], v8 offset:128
    ds_read_b64_tr_b16 v[84:85], v25 offset:8192
    ds_read_b64_tr_b16 v[86:87], v25 offset:10240
    ds_read_b128 v[88:91], v8 offset:192
    ds_read_b64_tr_b16 v[92:93], v25 offset:12288
    ds_read_b64_tr_b16 v[94:95], v25 offset:14336
    ds_read_b128 v[96:99], v8 offset:256
    ds_read_b64_tr_b16 v[100:101], v25 offset:16384
    ds_read_b64_tr_b16 v[102:103], v25 offset:18432
    ds_read_b128 v[104:107], v8 offset:320
    ds_read_b64_tr_b16 v[108:109], v25 offset:20480
    ds_read_b64_tr_b16 v[110:111], v25 offset:22528
    ds_read_b128 v[112:115], v8 offset:384
    ds_read_b64_tr_b16 v[116:117], v25 offset:24576
    ds_read_b64_tr_b16 v[118:119], v25 offset:26624
    ds_read_b128 v[120:123], v8 offset:448
    ds_read_b64_tr_b16 v[124:125], v25 offset:28672
    ds_read_b64_tr_b16 v[126:127], v25 offset:30720
    ds_read_b128 v[128:131], v8 offset:512
    ds_read_b64_tr_b16 v[132:133], v25 offset:32768
    ds_read_b64_tr_b16 v[134:135], v25 offset:34816
    ds_read_b128 v[136:139], v8 offset:576
    ds_read_b64_tr_b16 v[140:141], v25 offset:36864
    ds_read_b64_tr_b16 v[142:143], v25 offset:38912
    ds_read_b128 v[144:147], v8 offset:640
    ds_read_b64_tr_b16 v[148:149], v25 offset:40960
    ds_read_b64_tr_b16 v[150:151], v25 offset:43008
    ds_read_b128 v[152:155], v8 offset:704
    ds_read_b64_tr_b16 v[156:157], v25 offset:45056
    ds_read_b64_tr_b16 v[158:159], v25 offset:47104
    ds_read_b128 v[160:163], v8 offset:768
    ds_read_b64_tr_b16 v[164:165], v25 offset:49152
    ds_read_b64_tr_b16 v[166:167], v25 offset:51200
    ds_read_b128 v[168:171], v8 offset:832
    ds_read_b64_tr_b16 v[172:173], v25 offset:53248
    ds_read_b64_tr_b16 v[174:175], v25 offset:55296
    ds_read_b128 v[176:179], v8 offset:896
    ds_read_b64_tr_b16 v[180:181], v25 offset:57344
    ds_read_b64_tr_b16 v[182:183], v25 offset:59392
    ds_read_b128 v[184:187], v8 offset:960
    ds_read_b64_tr_b16 v[188:189], v25 offset:61440
    ds_read_b64_tr_b16 v[190:191], v25 offset:63488
    ds_read_b128 v[192:195], v8 offset:1024
    ds_read_b64_tr_b16 v[196:197], v56 offset:0
    ds_read_b64_tr_b16 v[198:199], v56 offset:2048
    ds_read_b128 v[200:203], v8 offset:1088
    ds_read_b64_tr_b16 v[204:205], v56 offset:4096
    ds_read_b64_tr_b16 v[206:207], v56 offset:6144
    ds_read_b128 v[208:211], v8 offset:1152
    ds_read_b64_tr_b16 v[212:213], v56 offset:8192
    ds_read_b64_tr_b16 v[214:215], v56 offset:10240
    ds_read_b128 v[216:219], v8 offset:1216
    ds_read_b64_tr_b16 v[220:221], v56 offset:12288
    ds_read_b64_tr_b16 v[222:223], v56 offset:14336
    s_waitcnt lgkmcnt(15)
    v_mfma_f32_16x16x32_bf16 v[28:31], v[64:67], v[68:71], 0
    s_waitcnt lgkmcnt(15)
    v_mfma_f32_16x16x32_bf16 v[28:31], v[72:75], v[76:79], v[28:31]
    s_waitcnt lgkmcnt(15)
    v_mfma_f32_16x16x32_bf16 v[28:31], v[80:83], v[84:87], v[28:31]
    s_waitcnt lgkmcnt(15)
    v_mfma_f32_16x16x32_bf16 v[28:31], v[88:91], v[92:95], v[28:31]
    s_waitcnt lgkmcnt(15)
    v_mfma_f32_16x16x32_bf16 v[28:31], v[96:99], v[100:103], v[28:31]
    s_waitcnt lgkmcnt(15)
    v_mfma_f32_16x16x32_bf16 v[28:31], v[104:107], v[108:111], v[28:31]
    s_waitcnt lgkmcnt(15)
    v_mfma_f32_16x16x32_bf16 v[28:31], v[112:115], v[116:119], v[28:31]
    s_waitcnt lgkmcnt(15)
    v_mfma_f32_16x16x32_bf16 v[28:31], v[120:123], v[124:127], v[28:31]
    s_waitcnt lgkmcnt(15)
    v_mfma_f32_16x16x32_bf16 v[28:31], v[128:131], v[132:135], v[28:31]
    s_waitcnt lgkmcnt(15)
    v_mfma_f32_16x16x32_bf16 v[28:31], v[136:139], v[140:143], v[28:31]
    s_waitcnt lgkmcnt(15)
    v_mfma_f32_16x16x32_bf16 v[28:31], v[144:147], v[148:151], v[28:31]
    s_waitcnt lgkmcnt(15)
    v_mfma_f32_16x16x32_bf16 v[28:31], v[152:155], v[156:159], v[28:31]
    s_waitcnt lgkmcnt(15)
    v_mfma_f32_16x16x32_bf16 v[28:31], v[160:163], v[164:167], v[28:31]
    s_waitcnt lgkmcnt(15)
    v_mfma_f32_16x16x32_bf16 v[28:31], v[168:171], v[172:175], v[28:31]
    s_waitcnt lgkmcnt(15)
    v_mfma_f32_16x16x32_bf16 v[28:31], v[176:179], v[180:183], v[28:31]
    s_waitcnt lgkmcnt(12)
    v_mfma_f32_16x16x32_bf16 v[28:31], v[184:187], v[188:191], v[28:31]
    s_waitcnt lgkmcnt(9)
    v_mfma_f32_16x16x32_bf16 v[28:31], v[192:195], v[196:199], v[28:31]
    s_waitcnt lgkmcnt(6)
    v_mfma_f32_16x16x32_bf16 v[28:31], v[200:203], v[204:207], v[28:31]
    s_waitcnt lgkmcnt(3)
    v_mfma_f32_16x16x32_bf16 v[28:31], v[208:211], v[212:215], v[28:31]
    s_waitcnt lgkmcnt(0)
    v_mfma_f32_16x16x32_bf16 v[28:31], v[216:219], v[220:223], v[28:31]
    s_mov_b64 s[100:101], exec
    s_mov_b64 exec, 1
    ds_add_u32 v61, v62 offset:76
    s_mov_b64 exec, s[100:101]
    s_nop 7
    s_mov_b64 s[48:49], exec
    s_mov_b64 exec, 0xffff
    v_cvt_pk_bf16_f32 v64, v28, v29
    v_cvt_pk_bf16_f32 v65, v30, v31
    v_mov_b32 v66, s36
    v_mov_b32 v67, s37
    global_store_dwordx4 v21, v[64:67], s[32:33] sc1
    s_mov_b64 exec, s[48:49]
L_B_no0n:
    s_mov_b32 s42, 0
    v_and_b32 v8, 3, v0
    v_mul_u32_u24 v8, 1344, v8
    v_lshlrev_b32 v9, 4, v2
    s_add_u32 s47, s42, 151552
    v_add3_u32 v8, v8, v9, s47
    v_add_u32 v5, 512, v3
    v_min_u32 v5, 639, v5
    v_lshlrev_b32 v4, 4, v3
    v_lshlrev_b32 v6, 4, v5
    v_add_u32 v7, 4096, v4
    v_lshlrev_b32 v10, 1, v3
    v_lshlrev_b32 v11, 1, v5
    v_add_u32 v12, 512, v10
    global_load_ushort v108, v10, s[4:5] offset:0
    global_load_ushort v112, v12, s[4:5] offset:0
    global_load_ushort v116, v11, s[4:5] offset:0
    global_load_ushort v109, v10, s[4:5] offset:1280
    global_load_ushort v113, v12, s[4:5] offset:1280
    global_load_ushort v117, v11, s[4:5] offset:1280
    global_load_ushort v110, v10, s[4:5] offset:2560
    global_load_ushort v114, v12, s[4:5] offset:2560
    global_load_ushort v118, v11, s[4:5] offset:2560
    global_load_ushort v111, v10, s[4:5] offset:3840
    global_load_ushort v115, v12, s[4:5] offset:3840
    global_load_ushort v119, v11, s[4:5] offset:3840
    v_add_u32 v12, 4096, v4
    v_add_u32 v13, 4096, v7
    v_add_u32 v14, 4096, v6
    v_add_u32 v200, 20480, v12
    v_add_u32 v201, 20480, v13
    v_add_u32 v202, 20480, v14
    v_add_u32 v203, 30720, v12
    v_add_u32 v204, 30720, v13
    v_add_u32 v205, 30720, v14
    v_add_u32 v206, 40960, v12
    v_add_u32 v207, 40960, v13
    v_add_u32 v208, 40960, v14
    s_mov_b32 s50, 0
L_poll_40:
    global_load_dwordx4 v[160:163], v200, s[32:33] sc1
    global_load_dwordx4 v[164:167], v201, s[32:33] sc1
    global_load_dwordx4 v[168:171], v202, s[32:33] sc1
    global_load_dwordx4 v[172:175], v203, s[32:33] sc1
    global_load_dwordx4 v[176:179], v204, s[32:33] sc1
    global_load_dwordx4 v[180:183], v205, s[32:33] sc1
    global_load_dwordx4 v[184:187], v206, s[32:33] sc1
    global_load_dwordx4 v[188:191], v207, s[32:33] sc1
    global_load_dwordx4 v[192:195], v208, s[32:33] sc1
    s_add_u32 s50, s50, 1
    s_waitcnt vmcnt(0)
    v_xor_b32 v58, s36, v162
    v_xor_b32 v59, s37, v163
    v_xor_b32 v57, s36, v166
    v_xor_b32 v56, s37, v167
    v_or3_b32 v58, v58, v57, v56
    v_xor_b32 v57, s36, v170
    v_xor_b32 v56, s37, v171
    v_or3_b32 v58, v58, v57, v56
    v_xor_b32 v57, s36, v174
    v_xor_b32 v56, s37, v175
    v_or3_b32 v58, v58, v57, v56
    v_xor_b32 v57, s36, v178
    v_xor_b32 v56, s37, v179
    v_or3_b32 v58, v58, v57, v56
    v_xor_b32 v57, s36, v182
    v_xor_b32 v56, s37, v183
    v_or3_b32 v58, v58, v57, v56
    v_xor_b32 v57, s36, v186
    v_xor_b32 v56, s37, v187
    v_or3_b32 v58, v58, v57, v56
    v_xor_b32 v57, s36, v190
    v_xor_b32 v56, s37, v191
    v_or3_b32 v58, v58, v57, v56
    v_xor_b32 v57, s36, v194
    v_xor_b32 v56, s37, v195
    v_or3_b32 v58, v58, v57, v56
    v_or_b32 v58, v58, v59
    v_cmp_ne_u32 vcc, 0, v58
    s_cmp_ge_u32 s50, 262144
    s_cbranch_scc1 L_polld_41
    s_cbranch_vccnz L_poll_40
L_polld_41:
    v_add_u32 v12, 8519680, v4
    v_add_u32 v13, 8519680, v7
    v_add_u32 v14, 8519680, v6
    v_add_u32 v15, 10240, v12
    v_add_u32 v16, 10240, v13
    v_add_u32 v17, 10240, v14
    v_and_b32 v20, 0xffffffe0, v3
    v_lshlrev_b32 v20, 1, v20
    v_bfe_u32 v56, v3, 2, 2
    v_lshlrev_b32 v56, 4, v56
    v_bfe_u32 v57, v3, 4, 1
    v_lshlrev_b32 v57, 3, v57
    v_add3_u32 v20, v20, v56, v57
    v_and_b32 v56, 3, v3
    v_lshlrev_b32 v56, 1, v56
    v_add_u32 v20, v20, v56
    v_add_u32 v20, 98304, v20
    v_and_b32 v21, 0xffffffe0, v5
    v_lshlrev_b32 v21, 1, v21
    v_bfe_u32 v56, v5, 2, 2
    v_lshlrev_b32 v56, 4, v56
    v_bfe_u32 v57, v5, 4, 1
    v_lshlrev_b32 v57, 3, v57
    v_add3_u32 v21, v21, v56, v57
    v_and_b32 v56, 3, v5
    v_lshlrev_b32 v56, 1, v56
    v_add_u32 v21, v21, v56
    v_add_u32 v21, 98304, v21
    v_lshlrev_b32 v108, 16, v108
    v_lshlrev_b32 v109, 16, v109
    v_lshlrev_b32 v110, 16, v110
    v_lshlrev_b32 v111, 16, v111
    v_lshlrev_b32 v120, 16, v160
    v_and_b32 v121, 0xffff0000, v160
    v_lshlrev_b32 v96, 16, v184
    v_and_b32 v97, 0xffff0000, v184
    v_add_f32 v96, 1.0, v96
    v_add_f32 v97, 1.0, v97
    v_cvt_pk_bf16_f32 v90, v96, v97
    ds_write_b16 v20, v90 offset:5376
    ds_write_b16_d16_hi v20, v90 offset:6720
    ds_write_b16 v20, v172 offset:10752
    ds_write_b16_d16_hi v20, v172 offset:12096
    v_lshlrev_b32 v96, 16, v90
    v_and_b32 v97, 0xffff0000, v90
    v_lshlrev_b32 v122, 16, v161
    v_and_b32 v123, 0xffff0000, v161
    v_lshlrev_b32 v98, 16, v185
    v_and_b32 v99, 0xffff0000, v185
    v_add_f32 v98, 1.0, v98
    v_add_f32 v99, 1.0, v99
    v_cvt_pk_bf16_f32 v90, v98, v99
    ds_write_b16 v20, v90 offset:8064
    ds_write_b16_d16_hi v20, v90 offset:9408
    ds_write_b16 v20, v173 offset:13440
    ds_write_b16_d16_hi v20, v173 offset:14784
    v_lshlrev_b32 v98, 16, v90
    v_and_b32 v99, 0xffff0000, v90
    v_lshlrev_b32 v112, 16, v112
    v_lshlrev_b32 v113, 16, v113
    v_lshlrev_b32 v114, 16, v114
    v_lshlrev_b32 v115, 16, v115
    v_lshlrev_b32 v124, 16, v164
    v_and_b32 v125, 0xffff0000, v164
    v_lshlrev_b32 v100, 16, v188
    v_and_b32 v101, 0xffff0000, v188
    v_add_f32 v100, 1.0, v100
    v_add_f32 v101, 1.0, v101
    v_cvt_pk_bf16_f32 v90, v100, v101
    ds_write_b16 v20, v90 offset:5888
    ds_write_b16_d16_hi v20, v90 offset:7232
    ds_write_b16 v20, v176 offset:11264
    ds_write_b16_d16_hi v20, v176 offset:12608
    v_lshlrev_b32 v100, 16, v90
    v_and_b32 v101, 0xffff0000, v90
    v_lshlrev_b32 v126, 16, v165
    v_and_b32 v127, 0xffff0000, v165
    v_lshlrev_b32 v102, 16, v189
    v_and_b32 v103, 0xffff0000, v189
    v_add_f32 v102, 1.0, v102
    v_add_f32 v103, 1.0, v103
    v_cvt_pk_bf16_f32 v90, v102, v103
    ds_write_b16 v20, v90 offset:8576
    ds_write_b16_d16_hi v20, v90 offset:9920
    ds_write_b16 v20, v177 offset:13952
    ds_write_b16_d16_hi v20, v177 offset:15296
    v_lshlrev_b32 v102, 16, v90
    v_and_b32 v103, 0xffff0000, v90
    v_lshlrev_b32 v116, 16, v116
    v_lshlrev_b32 v117, 16, v117
    v_lshlrev_b32 v118, 16, v118
    v_lshlrev_b32 v119, 16, v119
    v_lshlrev_b32 v128, 16, v168
    v_and_b32 v129, 0xffff0000, v168
    v_lshlrev_b32 v104, 16, v192
    v_and_b32 v105, 0xffff0000, v192
    v_add_f32 v104, 1.0, v104
    v_add_f32 v105, 1.0, v105
    v_cvt_pk_bf16_f32 v90, v104, v105
    ds_write_b16 v21, v90 offset:5376
    ds_write_b16_d16_hi v21, v90 offset:6720
    ds_write_b16 v21, v180 offset:10752
    ds_write_b16_d16_hi v21, v180 offset:12096
    v_lshlrev_b32 v104, 16, v90
    v_and_b32 v105, 0xffff0000, v90
    v_lshlrev_b32 v130, 16, v169
    v_and_b32 v131, 0xffff0000, v169
    v_lshlrev_b32 v106, 16, v193
    v_and_b32 v107, 0xffff0000, v193
    v_add_f32 v106, 1.0, v106
    v_add_f32 v107, 1.0, v107
    v_cvt_pk_bf16_f32 v90, v106, v107
    ds_write_b16 v21, v90 offset:8064
    ds_write_b16_d16_hi v21, v90 offset:9408
    ds_write_b16 v21, v181 offset:13440
    ds_write_b16_d16_hi v21, v181 offset:14784
    v_lshlrev_b32 v106, 16, v90
    v_and_b32 v107, 0xffff0000, v90
    s_and_b32 s46, s3, 1
    v_lshrrev_b32 v18, 2, v1
    v_lshl_add_u32 v18, v2, 2, v18
    v_lshlrev_b32 v10, 6, v18
    v_bfe_u32 v18, v1, 1, 1
    v_and_b32 v19, 1, v2
    v_lshlrev_b32 v19, 1, v19
    v_xor_b32 v18, v18, v19
    s_lshl_b32 s47, s46, 1
    v_xor_b32 v18, s47, v18
    v_lshl_add_u32 v10, v18, 4, v10
    v_and_b32 v18, 1, v1
    v_lshl_add_u32 v10, v18, 3, v10
    s_lshr_b32 s42, s3, 1
    s_mul_i32 s42, s42, 40960
    v_add_u32 v10, s42, v10
    s_lshl_b32 s42, s3, 5
    s_add_u32 s42, s42, 162048
    v_mov_b32 v18, s42
    v_and_b32 v19, 3, v1
    v_lshlrev_b32 v19, 2, v19
    v_add_u32 v19, 162048, v19
    v_cmp_gt_u32 vcc, 128, v3
    s_and_b32 s42, s3, 1
    s_lshl_b32 s43, s42, 10
    s_add_u32 s43, s43, 131072
    v_lshl_add_u32 v22, v0, 4, s43
    s_lshl_b32 s43, s54, 1
    s_add_u32 s42, s42, s43
    s_lshl_b32 s42, s42, 8
    s_add_u32 s42, s42, 8585216
    v_lshlrev_b32 v23, 6, v1
    v_lshl_add_u32 v23, v2, 4, v23
    v_add_u32 v23, s42, v23
    s_mov_b64 s[52:53], vcc
    v_cmp_gt_u32 vcc, 12, v1
    v_and_b32 v24, 3, v1
    s_nop 0
    v_cndmask_b32 v24, v24, v1, vcc
    v_mul_u32_u24 v8, 1344, v24
    v_lshlrev_b32 v24, 4, v2
    v_add_u32 v8, v8, v24
    v_add_u32 v8, 98304, v8
L_lw_42:
    s_sleep 1
    ds_read_b32 v63, v61 offset:52
    s_waitcnt lgkmcnt(0)
    v_readfirstlane_b32 s59, v63
    s_cmp_lt_u32 s59, 4
    s_cbranch_scc1 L_lw_42
    ds_read_b64_tr_b16 v[160:161], v10 offset:0
    ds_read_b64_tr_b16 v[162:163], v10 offset:1024
    ds_read_b64_tr_b16 v[164:165], v10 offset:2048
    ds_read_b64_tr_b16 v[166:167], v10 offset:3072
    ds_read_b64_tr_b16 v[168:169], v10 offset:4096
    ds_read_b64_tr_b16 v[170:171], v10 offset:5120
    ds_read_b64_tr_b16 v[172:173], v10 offset:6144
    ds_read_b64_tr_b16 v[174:175], v10 offset:7168
    ds_read_b64_tr_b16 v[176:177], v10 offset:8192
    ds_read_b64_tr_b16 v[178:179], v10 offset:9216
    ds_read_b64_tr_b16 v[180:181], v10 offset:10240
    ds_read_b64_tr_b16 v[182:183], v10 offset:11264
    ds_read_b64_tr_b16 v[184:185], v10 offset:12288
    ds_read_b64_tr_b16 v[186:187], v10 offset:13312
    ds_read_b64_tr_b16 v[188:189], v10 offset:14336
    ds_read_b64_tr_b16 v[190:191], v10 offset:15360
    ds_read_b64_tr_b16 v[192:193], v10 offset:16384
    ds_read_b64_tr_b16 v[194:195], v10 offset:17408
    ds_read_b64_tr_b16 v[196:197], v10 offset:18432
    ds_read_b64_tr_b16 v[198:199], v10 offset:19456
    ds_read_b64_tr_b16 v[200:201], v10 offset:20480
    ds_read_b64_tr_b16 v[202:203], v10 offset:21504
    ds_read_b64_tr_b16 v[204:205], v10 offset:22528
    ds_read_b64_tr_b16 v[206:207], v10 offset:23552
    ds_read_b64_tr_b16 v[208:209], v10 offset:24576
    ds_read_b64_tr_b16 v[210:211], v10 offset:25600
    ds_read_b64_tr_b16 v[212:213], v10 offset:26624
    ds_read_b64_tr_b16 v[214:215], v10 offset:27648
    ds_read_b64_tr_b16 v[216:217], v10 offset:28672
    ds_read_b64_tr_b16 v[218:219], v10 offset:29696
    ds_read_b64_tr_b16 v[220:221], v10 offset:30720
    ds_read_b64_tr_b16 v[222:223], v10 offset:31744
    ds_read_b64_tr_b16 v[224:225], v10 offset:32768
    ds_read_b64_tr_b16 v[226:227], v10 offset:33792
    ds_read_b64_tr_b16 v[228:229], v10 offset:34816
    ds_read_b64_tr_b16 v[230:231], v10 offset:35840
    ds_read_b64_tr_b16 v[232:233], v10 offset:36864
    ds_read_b64_tr_b16 v[234:235], v10 offset:37888
    ds_read_b64_tr_b16 v[236:237], v10 offset:38912
    ds_read_b64_tr_b16 v[238:239], v10 offset:39936
    s_waitcnt lgkmcnt(0)
    s_mov_b32 s50, 0
L_poll_43:
    global_load_dwordx4 v[64:67], v12, s[32:33] sc1
    global_load_dwordx4 v[68:71], v13, s[32:33] sc1
    global_load_dwordx4 v[72:75], v14, s[32:33] sc1
    global_load_dwordx4 v[76:79], v15, s[32:33] sc1
    global_load_dwordx4 v[80:83], v16, s[32:33] sc1
    global_load_dwordx4 v[84:87], v17, s[32:33] sc1
    s_add_u32 s50, s50, 1
    s_waitcnt vmcnt(0)
    v_xor_b32 v58, s36, v66
    v_xor_b32 v59, s37, v67
    v_xor_b32 v57, s36, v70
    v_xor_b32 v56, s37, v71
    v_or3_b32 v58, v58, v57, v56
    v_xor_b32 v57, s36, v74
    v_xor_b32 v56, s37, v75
    v_or3_b32 v58, v58, v57, v56
    v_xor_b32 v57, s36, v78
    v_xor_b32 v56, s37, v79
    v_or3_b32 v58, v58, v57, v56
    v_xor_b32 v57, s36, v82
    v_xor_b32 v56, s37, v83
    v_or3_b32 v58, v58, v57, v56
    v_xor_b32 v57, s36, v86
    v_xor_b32 v56, s37, v87
    v_or3_b32 v58, v58, v57, v56
    v_or_b32 v58, v58, v59
    v_cmp_ne_u32 vcc, 0, v58
    s_cmp_ge_u32 s50, 262144
    s_cbranch_scc1 L_polld_44
    s_cbranch_vccnz L_poll_43
L_polld_44:
    v_lshlrev_b32 v90, 16, v64
    v_and_b32 v91, 0xffff0000, v64
    v_lshlrev_b32 v92, 16, v76
    v_and_b32 v93, 0xffff0000, v76
    v_pk_add_f32 v[90:91], v[90:91], v[92:93]
    v_pk_fma_f32 v[90:91], v[90:91], v[120:121], v[108:109]
    v_cvt_pk_bf16_f32 v90, v90, v91
    v_lshlrev_b32 v132, 16, v90
    v_and_b32 v133, 0xffff0000, v90
    v_pk_mul_f32 v[90:91], v[132:133], v[96:97]
    v_cvt_pk_bf16_f32 v90, v90, v91
    ds_write_b16 v20, v90 offset:0
    ds_write_b16_d16_hi v20, v90 offset:1344
    v_lshlrev_b32 v90, 16, v65
    v_and_b32 v91, 0xffff0000, v65
    v_lshlrev_b32 v92, 16, v77
    v_and_b32 v93, 0xffff0000, v77
    v_pk_add_f32 v[90:91], v[90:91], v[92:93]
    v_pk_fma_f32 v[90:91], v[90:91], v[122:123], v[110:111]
    v_cvt_pk_bf16_f32 v90, v90, v91
    v_lshlrev_b32 v134, 16, v90
    v_and_b32 v135, 0xffff0000, v90
    v_pk_mul_f32 v[90:91], v[134:135], v[98:99]
    v_cvt_pk_bf16_f32 v90, v90, v91
    ds_write_b16 v20, v90 offset:2688
    ds_write_b16_d16_hi v20, v90 offset:4032
    v_lshlrev_b32 v90, 16, v68
    v_and_b32 v91, 0xffff0000, v68
    v_lshlrev_b32 v92, 16, v80
    v_and_b32 v93, 0xffff0000, v80
    v_pk_add_f32 v[90:91], v[90:91], v[92:93]
    v_pk_fma_f32 v[90:91], v[90:91], v[124:125], v[112:113]
    v_cvt_pk_bf16_f32 v90, v90, v91
    v_lshlrev_b32 v136, 16, v90
    v_and_b32 v137, 0xffff0000, v90
    v_pk_mul_f32 v[90:91], v[136:137], v[100:101]
    v_cvt_pk_bf16_f32 v90, v90, v91
    ds_write_b16 v20, v90 offset:512
    ds_write_b16_d16_hi v20, v90 offset:1856
    v_lshlrev_b32 v90, 16, v69
    v_and_b32 v91, 0xffff0000, v69
    v_lshlrev_b32 v92, 16, v81
    v_and_b32 v93, 0xffff0000, v81
    v_pk_add_f32 v[90:91], v[90:91], v[92:93]
    v_pk_fma_f32 v[90:91], v[90:91], v[126:127], v[114:115]
    v_cvt_pk_bf16_f32 v90, v90, v91
    v_lshlrev_b32 v138, 16, v90
    v_and_b32 v139, 0xffff0000, v90
    v_pk_mul_f32 v[90:91], v[138:139], v[102:103]
    v_cvt_pk_bf16_f32 v90, v90, v91
    ds_write_b16 v20, v90 offset:3200
    ds_write_b16_d16_hi v20, v90 offset:4544
    v_lshlrev_b32 v90, 16, v72
    v_and_b32 v91, 0xffff0000, v72
    v_lshlrev_b32 v92, 16, v84
    v_and_b32 v93, 0xffff0000, v84
    v_pk_add_f32 v[90:91], v[90:91], v[92:93]
    v_pk_fma_f32 v[90:91], v[90:91], v[128:129], v[116:117]
    v_cvt_pk_bf16_f32 v90, v90, v91
    v_lshlrev_b32 v140, 16, v90
    v_and_b32 v141, 0xffff0000, v90
    v_pk_mul_f32 v[90:91], v[140:141], v[104:105]
    v_cvt_pk_bf16_f32 v90, v90, v91
    ds_write_b16 v21, v90 offset:0
    ds_write_b16_d16_hi v21, v90 offset:1344
    v_lshlrev_b32 v90, 16, v73
    v_and_b32 v91, 0xffff0000, v73
    v_lshlrev_b32 v92, 16, v85
    v_and_b32 v93, 0xffff0000, v85
    v_pk_add_f32 v[90:91], v[90:91], v[92:93]
    v_pk_fma_f32 v[90:91], v[90:91], v[130:131], v[118:119]
    v_cvt_pk_bf16_f32 v90, v90, v91
    v_lshlrev_b32 v142, 16, v90
    v_and_b32 v143, 0xffff0000, v90
    v_pk_mul_f32 v[90:91], v[142:143], v[106:107]
    v_cvt_pk_bf16_f32 v90, v90, v91
    ds_write_b16 v21, v90 offset:2688
    ds_write_b16_d16_hi v21, v90 offset:4032
    s_mov_b64 s[100:101], exec
    s_mov_b64 exec, 1
    ds_add_u32 v61, v62 offset:56
    s_mov_b64 exec, s[100:101]
    v_cndmask_b32 v90, 0, v140, s[52:53]
    v_add_f32 v144, v132, v136
    v_add_f32 v144, v144, v90
    v_mul_f32 v148, v132, v132
    v_fmac_f32 v148, v136, v136
    v_fmac_f32 v148, v90, v90
    v_cndmask_b32 v90, 0, v141, s[52:53]
    v_add_f32 v145, v133, v137
    v_add_f32 v145, v145, v90
    v_mul_f32 v149, v133, v133
    v_fmac_f32 v149, v137, v137
    v_fmac_f32 v149, v90, v90
    v_cndmask_b32 v90, 0, v142, s[52:53]
    v_add_f32 v146, v134, v138
    v_add_f32 v146, v146, v90
    v_mul_f32 v150, v134, v134
    v_fmac_f32 v150, v138, v138
    v_fmac_f32 v150, v90, v90
    v_cndmask_b32 v90, 0, v143, s[52:53]
    v_add_f32 v147, v135, v139
    v_add_f32 v147, v147, v90
    v_mul_f32 v151, v135, v135
    v_fmac_f32 v151, v139, v139
    v_fmac_f32 v151, v90, v90
    v_add_f32_dpp v144, v144, v144 quad_perm:[1,0,3,2] row_mask:0xf bank_mask:0xf
    v_add_f32_dpp v145, v145, v145 quad_perm:[1,0,3,2] row_mask:0xf bank_mask:0xf
    v_add_f32_dpp v146, v146, v146 quad_perm:[1,0,3,2] row_mask:0xf bank_mask:0xf
    v_add_f32_dpp v147, v147, v147 quad_perm:[1,0,3,2] row_mask:0xf bank_mask:0xf
    v_add_f32_dpp v148, v148, v148 quad_perm:[1,0,3,2] row_mask:0xf bank_mask:0xf
    v_add_f32_dpp v149, v149, v149 quad_perm:[1,0,3,2] row_mask:0xf bank_mask:0xf
    v_add_f32_dpp v150, v150, v150 quad_perm:[1,0,3,2] row_mask:0xf bank_mask:0xf
    v_add_f32_dpp v151, v151, v151 quad_perm:[1,0,3,2] row_mask:0xf bank_mask:0xf
    v_add_f32_dpp v144, v144, v144 quad_perm:[2,3,0,1] row_mask:0xf bank_mask:0xf
    v_add_f32_dpp v145, v145, v145 quad_perm:[2,3,0,1] row_mask:0xf bank_mask:0xf
    v_add_f32_dpp v146, v146, v146 quad_perm:[2,3,0,1] row_mask:0xf bank_mask:0xf
    v_add_f32_dpp v147, v147, v147 quad_perm:[2,3,0,1] row_mask:0xf bank_mask:0xf
    v_add_f32_dpp v148, v148, v148 quad_perm:[2,3,0,1] row_mask:0xf bank_mask:0xf
    v_add_f32_dpp v149, v149, v149 quad_perm:[2,3,0,1] row_mask:0xf bank_mask:0xf
    v_add_f32_dpp v150, v150, v150 quad_perm:[2,3,0,1] row_mask:0xf bank_mask:0xf
    v_add_f32_dpp v151, v151, v151 quad_perm:[2,3,0,1] row_mask:0xf bank_mask:0xf
    v_add_f32_dpp v144, v144, v144 row_half_mirror row_mask:0xf bank_mask:0xf
    v_add_f32_dpp v145, v145, v145 row_half_mirror row_mask:0xf bank_mask:0xf
    v_add_f32_dpp v146, v146, v146 row_half_mirror row_mask:0xf bank_mask:0xf
    v_add_f32_dpp v147, v147, v147 row_half_mirror row_mask:0xf bank_mask:0xf
    v_add_f32_dpp v148, v148, v148 row_half_mirror row_mask:0xf bank_mask:0xf
    v_add_f32_dpp v149, v149, v149 row_half_mirror row_mask:0xf bank_mask:0xf
    v_add_f32_dpp v150, v150, v150 row_half_mirror row_mask:0xf bank_mask:0xf
    v_add_f32_dpp v151, v151, v151 row_half_mirror row_mask:0xf bank_mask:0xf
    v_add_f32_dpp v144, v144, v144 row_mirror row_mask:0xf bank_mask:0xf
    v_add_f32_dpp v145, v145, v145 row_mirror row_mask:0xf bank_mask:0xf
    v_add_f32_dpp v146, v146, v146 row_mirror row_mask:0xf bank_mask:0xf
    v_add_f32_dpp v147, v147, v147 row_mirror row_mask:0xf bank_mask:0xf
    v_add_f32_dpp v148, v148, v148 row_mirror row_mask:0xf bank_mask:0xf
    v_add_f32_dpp v149, v149, v149 row_mirror row_mask:0xf bank_mask:0xf
    v_add_f32_dpp v150, v150, v150 row_mirror row_mask:0xf bank_mask:0xf
    v_add_f32_dpp v151, v151, v151 row_mirror row_mask:0xf bank_mask:0xf
    v_mov_b32 v152, v144
    v_mov_b32 v153, v145
    v_mov_b32 v154, v146
    v_mov_b32 v155, v147
    v_mov_b32 v156, v148
    v_mov_b32 v157, v149
    v_mov_b32 v158, v150
    v_mov_b32 v159, v151
    v_permlane16_swap_b32 v144, v152
    v_permlane16_swap_b32 v145, v153
    v_permlane16_swap_b32 v146, v154
    v_permlane16_swap_b32 v147, v155
    v_permlane16_swap_b32 v148, v156
    v_permlane16_swap_b32 v149, v157
    v_permlane16_swap_b32 v150, v158
    v_permlane16_swap_b32 v151, v159
    v_add_f32 v144, v144, v152
    v_add_f32 v145, v145, v153
    v_add_f32 v146, v146, v154
    v_add_f32 v147, v147, v155
    v_add_f32 v148, v148, v156
    v_add_f32 v149, v149, v157
    v_add_f32 v150, v150, v158
    v_add_f32 v151, v151, v159
    v_mov_b32 v152, v144
    v_mov_b32 v153, v145
    v_mov_b32 v154, v146
    v_mov_b32 v155, v147
    v_mov_b32 v156, v148
    v_mov_b32 v157, v149
    v_mov_b32 v158, v150
    v_mov_b32 v159, v151
    v_permlane32_swap_b32 v144, v152
    v_permlane32_swap_b32 v145, v153
    v_permlane32_swap_b32 v146, v154
    v_permlane32_swap_b32 v147, v155
    v_permlane32_swap_b32 v148, v156
    v_permlane32_swap_b32 v149, v157
    v_permlane32_swap_b32 v150, v158
    v_permlane32_swap_b32 v151, v159
    v_add_f32 v144, v144, v152
    v_add_f32 v145, v145, v153
    v_add_f32 v146, v146, v154
    v_add_f32 v147, v147, v155
    v_add_f32 v148, v148, v156
    v_add_f32 v149, v149, v157
    v_add_f32 v150, v150, v158
    v_add_f32 v151, v151, v159
    s_mov_b64 s[48:49], exec
    s_mov_b64 exec, 1
    ds_write_b128 v18, v[144:147]
    ds_write_b128 v18, v[148:151] offset:16
    s_mov_b64 exec, s[48:49]
    s_mov_b64 s[100:101], exec
    s_mov_b64 exec, 1
    ds_add_u32 v61, v62 offset:48
    s_mov_b64 exec, s[100:101]
L_lw_45:
    ds_read_b32 v63, v61 offset:56
    s_waitcnt lgkmcnt(0)
    v_readfirstlane_b32 s59, v63
    s_cmp_lt_u32 s59, 4
    s_cbranch_scc1 L_lw_45
    s_waitcnt vmcnt(0)
    ds_read_b128 v[64:67], v8 offset:0
    ds_read_b128 v[68:71], v8 offset:64
    ds_read_b128 v[72:75], v8 offset:128
    ds_read_b128 v[76:79], v8 offset:192
    ds_read_b128 v[80:83], v8 offset:256
    ds_read_b128 v[84:87], v8 offset:320
    ds_read_b128 v[88:91], v8 offset:384
    ds_read_b128 v[92:95], v8 offset:448
    ds_read_b128 v[96:99], v8 offset:512
    ds_read_b128 v[100:103], v8 offset:576
    ds_read_b128 v[104:107], v8 offset:640
    ds_read_b128 v[108:111], v8 offset:704
    ds_read_b128 v[112:115], v8 offset:768
    ds_read_b128 v[116:119], v8 offset:832
    ds_read_b128 v[120:123], v8 offset:896
    ds_read_b128 v[124:127], v8 offset:960
    ds_read_b128 v[128:131], v8 offset:1024
    ds_read_b128 v[132:135], v8 offset:1088
    ds_read_b128 v[136:139], v8 offset:1152
    ds_read_b128 v[140:143], v8 offset:1216
    s_waitcnt lgkmcnt(15)
    v_mfma_f32_16x16x32_bf16 v[28:31], v[160:163], v[64:67], 0
    s_waitcnt lgkmcnt(15)
    v_mfma_f32_16x16x32_bf16 v[28:31], v[164:167], v[68:71], v[28:31]
    s_waitcnt lgkmcnt(15)
    v_mfma_f32_16x16x32_bf16 v[28:31], v[168:171], v[72:75], v[28:31]
    s_waitcnt lgkmcnt(15)
    v_mfma_f32_16x16x32_bf16 v[28:31], v[172:175], v[76:79], v[28:31]
    s_waitcnt lgkmcnt(15)
    v_mfma_f32_16x16x32_bf16 v[28:31], v[176:179], v[80:83], v[28:31]
    s_waitcnt lgkmcnt(14)
    v_mfma_f32_16x16x32_bf16 v[28:31], v[180:183], v[84:87], v[28:31]
    s_waitcnt lgkmcnt(13)
    v_mfma_f32_16x16x32_bf16 v[28:31], v[184:187], v[88:91], v[28:31]
    s_waitcnt lgkmcnt(12)
    v_mfma_f32_16x16x32_bf16 v[28:31], v[188:191], v[92:95], v[28:31]
    s_waitcnt lgkmcnt(11)
    v_mfma_f32_16x16x32_bf16 v[28:31], v[192:195], v[96:99], v[28:31]
    s_waitcnt lgkmcnt(10)
    v_mfma_f32_16x16x32_bf16 v[28:31], v[196:199], v[100:103], v[28:31]
    s_waitcnt lgkmcnt(9)
    v_mfma_f32_16x16x32_bf16 v[28:31], v[200:203], v[104:107], v[28:31]
    s_waitcnt lgkmcnt(8)
    v_mfma_f32_16x16x32_bf16 v[28:31], v[204:207], v[108:111], v[28:31]
    s_waitcnt lgkmcnt(7)
    v_mfma_f32_16x16x32_bf16 v[28:31], v[208:211], v[112:115], v[28:31]
    s_waitcnt lgkmcnt(6)
    v_mfma_f32_16x16x32_bf16 v[28:31], v[212:215], v[116:119], v[28:31]
    s_waitcnt lgkmcnt(5)
    v_mfma_f32_16x16x32_bf16 v[28:31], v[216:219], v[120:123], v[28:31]
    s_waitcnt lgkmcnt(4)
    v_mfma_f32_16x16x32_bf16 v[28:31], v[220:223], v[124:127], v[28:31]
    s_waitcnt lgkmcnt(3)
    v_mfma_f32_16x16x32_bf16 v[28:31], v[224:227], v[128:131], v[28:31]
    s_waitcnt lgkmcnt(2)
    v_mfma_f32_16x16x32_bf16 v[28:31], v[228:231], v[132:135], v[28:31]
    s_waitcnt lgkmcnt(1)
    v_mfma_f32_16x16x32_bf16 v[28:31], v[232:235], v[136:139], v[28:31]
    s_waitcnt lgkmcnt(0)
    v_mfma_f32_16x16x32_bf16 v[28:31], v[236:239], v[140:143], v[28:31]
L_lw_46:
    ds_read_b32 v63, v61 offset:48
    s_waitcnt lgkmcnt(0)
    v_readfirstlane_b32 s59, v63
    s_cmp_lt_u32 s59, 4
    s_cbranch_scc1 L_lw_46
    ds_read_b32 v144, v19 offset:0
    ds_read_b32 v148, v19 offset:16
    ds_read_b32 v145, v19 offset:32
    ds_read_b32 v149, v19 offset:48
    ds_read_b32 v146, v19 offset:64
    ds_read_b32 v150, v19 offset:80
    ds_read_b32 v147, v19 offset:96
    ds_read_b32 v151, v19 offset:112
    v_mov_b32_dpp v64, v28 row_shl:4 row_mask:0xf bank_mask:0xf
    v_mov_b32_dpp v65, v29 row_shl:4 row_mask:0xf bank_mask:0xf
    v_mov_b32_dpp v66, v30 row_shl:4 row_mask:0xf bank_mask:0xf
    v_mov_b32_dpp v67, v31 row_shl:4 row_mask:0xf bank_mask:0xf
    v_mov_b32_dpp v68, v28 row_shl:8 row_mask:0xf bank_mask:0xf
    v_mov_b32_dpp v69, v29 row_shl:8 row_mask:0xf bank_mask:0xf
    v_mov_b32_dpp v70, v30 row_shl:8 row_mask:0xf bank_mask:0xf
    v_mov_b32_dpp v71, v31 row_shl:8 row_mask:0xf bank_mask:0xf
    s_mov_b32 s43, 0x3acccccd
    s_waitcnt lgkmcnt(0)
    v_add_f32 v144, v144, v145
    v_add_f32 v146, v146, v147
    v_add_f32 v148, v148, v149
    v_add_f32 v150, v150, v151
    v_add_f32 v144, v144, v146
    v_add_f32 v148, v148, v150
    v_mul_f32 v144, s43, v144
    v_mul_f32 v148, s43, v148
    v_fma_f32 v148, -v144, v144, v148
    v_add_f32 v148, 0x3727c5ac, v148
    v_rsq_f32 v148, v148
    v_fma_f32 v28, -v144, v64, v28
    v_fma_f32 v29, -v144, v65, v29
    v_fma_f32 v30, -v144, v66, v30
    v_fma_f32 v31, -v144, v67, v31
    v_fma_f32 v28, v28, v148, v68
    v_fma_f32 v29, v29, v148, v69
    v_fma_f32 v30, v30, v148, v70
    v_fma_f32 v31, v31, v148, v71
    s_cmp_lt_u32 s3, 2
    s_cbranch_scc1 L_p6w_47
    ds_write_b128 v22, v[28:31]
    s_mov_b64 s[100:101], exec
    s_mov_b64 exec, 1
    ds_add_u32 v61, v62 offset:60
    s_mov_b64 exec, s[100:101]
    s_branch L_fin
L_p6w_47:
    s_mov_b32 s42, 0x3d372713
    s_mov_b32 s43, 0xc0135761
    v_mul_f32 v70, v28, v28
    v_mul_f32 v71, v29, v29
    v_mul_f32 v72, v30, v30
    v_mul_f32 v73, v31, v31
    v_mul_f32 v70, s42, v70
    v_mul_f32 v71, s42, v71
    v_mul_f32 v72, s42, v72
    v_mul_f32 v73, s42, v73
    v_fma_f32 v70, v70, v28, v28
    v_fma_f32 v71, v71, v29, v29
    v_fma_f32 v72, v72, v30, v30
    v_fma_f32 v73, v73, v31, v31
    v_mul_f32 v70, s43, v70
    v_mul_f32 v71, s43, v71
    v_mul_f32 v72, s43, v72
    v_mul_f32 v73, s43, v73
    v_exp_f32 v70, v70
    v_exp_f32 v71, v71
    v_exp_f32 v72, v72
    v_exp_f32 v73, v73
    v_add_f32 v70, 1.0, v70
    v_add_f32 v71, 1.0, v71
    v_add_f32 v72, 1.0, v72
    v_add_f32 v73, 1.0, v73
    v_rcp_f32 v70, v70
    v_rcp_f32 v71, v71
    v_rcp_f32 v72, v72
    v_rcp_f32 v73, v73
    v_mul_f32 v28, v28, v70
    v_mul_f32 v29, v29, v71
    v_mul_f32 v30, v30, v72
    v_mul_f32 v31, v31, v73
L_lw_48:
    ds_read_b32 v63, v61 offset:60
    s_waitcnt lgkmcnt(0)
    v_readfirstlane_b32 s59, v63
    s_cmp_lt_u32 s59, 6
    s_cbranch_scc1 L_lw_48
    ds_read_b128 v[64:67], v22
    s_waitcnt lgkmcnt(0)
    v_mul_f32 v28, v28, v64
    v_mul_f32 v29, v29, v65
    v_mul_f32 v30, v30, v66
    v_mul_f32 v31, v31, v67
    s_mov_b64 s[48:49], exec
    s_mov_b64 exec, s[96:97]
    v_cvt_pk_bf16_f32 v64, v28, v29
    v_cvt_pk_bf16_f32 v65, v30, v31
    v_mov_b32 v66, s36
    v_mov_b32 v67, s37
    global_store_dwordx4 v23, v[64:67], s[32:33] sc1
    s_mov_b64 exec, s[48:49]
    s_branch L_fin
L_A_l:
    s_lshl_b32 s47, s34, 4
    s_add_u32 s46, s47, s35
    s_lshl_b32 s46, s46, 17
    s_lshl_b32 s47, s40, 10
    s_add_u32 s46, s46, s47
    s_add_u32 s56, s6, s46
    s_addc_u32 s57, s7, 0
    s_mov_b32 s58, s47
    s_lshl_b32 s47, s40, 1
    v_xor_b32 v7, s47, v0
    v_xor_b32 v8, 0, v7
    v_lshlrev_b32 v8, 4, v8
    v_xor_b32 v9, 8, v7
    v_lshlrev_b32 v9, 4, v9
    v_xor_b32 v10, 9, v7
    v_lshlrev_b32 v10, 4, v10
    v_xor_b32 v11, 1, v7
    v_lshlrev_b32 v11, 4, v11
    s_add_u32 m0, s58, 0
    s_nop 0
    global_load_lds_dwordx4 v8, s[56:57] nt
    s_add_u32 s56, s56, 4096
    s_addc_u32 s57, s57, 0
    s_add_u32 m0, s58, 4096
    s_nop 0
    global_load_lds_dwordx4 v9, s[56:57] nt
    s_add_u32 s56, s56, 4096
    s_addc_u32 s57, s57, 0
    s_waitcnt vmcnt(0)
    s_add_u32 m0, s58, 8192
    s_nop 0
    global_load_lds_dwordx4 v10, s[56:57] nt
    s_add_u32 s56, s56, 4096
    s_addc_u32 s57, s57, 0
    s_add_u32 m0, s58, 12288
    s_nop 0
    global_load_lds_dwordx4 v11, s[56:57] nt
    s_add_u32 s56, s56, 4096
    s_addc_u32 s57, s57, 0
    s_add_u32 m0, s58, 16384
    s_nop 0
    global_load_lds_dwordx4 v8, s[56:57] nt
    s_add_u32 s56, s56, 4096
    s_addc_u32 s57, s57, 0
    s_add_u32 m0, s58, 20480
    s_nop 0
    global_load_lds_dwordx4 v9, s[56:57] nt
    s_add_u32 s56, s56, 4096
    s_addc_u32 s57, s57, 0
    s_add_u32 m0, s58, 24576
    s_nop 0
    global_load_lds_dwordx4 v10, s[56:57] nt
    s_add_u32 s56, s56, 4096
    s_addc_u32 s57, s57, 0
    s_add_u32 m0, s58, 28672
    s_nop 0
    global_load_lds_dwordx4 v11, s[56:57] nt
    s_add_u32 s56, s56, 4096
    s_addc_u32 s57, s57, 0
    s_waitcnt vmcnt(7)
    s_add_u32 m0, s58, 32768
    s_nop 0
    global_load_lds_dwordx4 v8, s[56:57] nt
    s_add_u32 s56, s56, 4096
    s_addc_u32 s57, s57, 0
    s_waitcnt vmcnt(7)
    s_add_u32 m0, s58, 36864
    s_nop 0
    global_load_lds_dwordx4 v9, s[56:57] nt
    s_add_u32 s56, s56, 4096
    s_addc_u32 s57, s57, 0
    s_waitcnt vmcnt(7)
    s_add_u32 m0, s58, 40960
    s_nop 0
    global_load_lds_dwordx4 v10, s[56:57] nt
    s_add_u32 s56, s56, 4096
    s_addc_u32 s57, s57, 0
    s_waitcnt vmcnt(7)
    s_add_u32 m0, s58, 45056
    s_nop 0
    global_load_lds_dwordx4 v11, s[56:57] nt
    s_add_u32 s56, s56, 4096
    s_addc_u32 s57, s57, 0
    s_waitcnt vmcnt(7)
    s_add_u32 m0, s58, 49152
    s_nop 0
    global_load_lds_dwordx4 v8, s[56:57] nt
    s_add_u32 s56, s56, 4096
    s_addc_u32 s57, s57, 0
    s_waitcnt vmcnt(7)
    s_add_u32 m0, s58, 53248
    s_nop 0
    global_load_lds_dwordx4 v9, s[56:57] nt
    s_add_u32 s56, s56, 4096
    s_addc_u32 s57, s57, 0
    s_waitcnt vmcnt(7)
    s_add_u32 m0, s58, 57344
    s_nop 0
    global_load_lds_dwordx4 v10, s[56:57] nt
    s_add_u32 s56, s56, 4096
    s_addc_u32 s57, s57, 0
    s_waitcnt vmcnt(7)
    s_add_u32 m0, s58, 61440
    s_nop 0
    global_load_lds_dwordx4 v11, s[56:57] nt
    s_add_u32 s56, s56, 4096
    s_addc_u32 s57, s57, 0
    s_waitcnt vmcnt(7)
    s_add_u32 m0, s58, 65536
    s_nop 0
    global_load_lds_dwordx4 v8, s[56:57] nt
    s_add_u32 s56, s56, 4096
    s_addc_u32 s57, s57, 0
    s_waitcnt vmcnt(7)
    s_add_u32 m0, s58, 69632
    s_nop 0
    global_load_lds_dwordx4 v9, s[56:57] nt
    s_add_u32 s56, s56, 4096
    s_addc_u32 s57, s57, 0
    s_waitcnt vmcnt(7)
    s_add_u32 m0, s58, 73728
    s_nop 0
    global_load_lds_dwordx4 v10, s[56:57] nt
    s_add_u32 s56, s56, 4096
    s_addc_u32 s57, s57, 0
    s_waitcnt vmcnt(7)
    s_add_u32 m0, s58, 77824
    s_nop 0
    global_load_lds_dwordx4 v11, s[56:57] nt
    s_add_u32 s56, s56, 4096
    s_addc_u32 s57, s57, 0
    s_waitcnt vmcnt(7)
    s_add_u32 m0, s58, 81920
    s_nop 0
    global_load_lds_dwordx4 v8, s[56:57] nt
    s_add_u32 s56, s56, 4096
    s_addc_u32 s57, s57, 0
    s_waitcnt vmcnt(7)
    s_add_u32 m0, s58, 86016
    s_nop 0
    global_load_lds_dwordx4 v9, s[56:57] nt
    s_add_u32 s56, s56, 4096
    s_addc_u32 s57, s57, 0
    s_waitcnt vmcnt(7)
    s_add_u32 m0, s58, 90112
    s_nop 0
    global_load_lds_dwordx4 v10, s[56:57] nt
    s_add_u32 s56, s56, 4096
    s_addc_u32 s57, s57, 0
    s_waitcnt vmcnt(7)
    s_add_u32 m0, s58, 94208
    s_nop 0
    global_load_lds_dwordx4 v11, s[56:57] nt
    s_add_u32 s56, s56, 4096
    s_addc_u32 s57, s57, 0
    s_waitcnt vmcnt(7)
    s_add_u32 m0, s58, 98304
    s_nop 0
    global_load_lds_dwordx4 v8, s[56:57] nt
    s_add_u32 s56, s56, 4096
    s_addc_u32 s57, s57, 0
    s_waitcnt vmcnt(7)
    s_add_u32 m0, s58, 102400
    s_nop 0
    global_load_lds_dwordx4 v9, s[56:57] nt
    s_add_u32 s56, s56, 4096
    s_addc_u32 s57, s57, 0
    s_waitcnt vmcnt(7)
    s_add_u32 m0, s58, 106496
    s_nop 0
    global_load_lds_dwordx4 v10, s[56:57] nt
    s_add_u32 s56, s56, 4096
    s_addc_u32 s57, s57, 0
    s_waitcnt vmcnt(7)
    s_add_u32 m0, s58, 110592
    s_nop 0
    global_load_lds_dwordx4 v11, s[56:57] nt
    s_add_u32 s56, s56, 4096
    s_addc_u32 s57, s57, 0
    s_waitcnt vmcnt(7)
    s_add_u32 m0, s58, 114688
    s_nop 0
    global_load_lds_dwordx4 v8, s[56:57] nt
    s_add_u32 s56, s56, 4096
    s_addc_u32 s57, s57, 0
    s_waitcnt vmcnt(7)
    s_add_u32 m0, s58, 118784
    s_nop 0
    global_load_lds_dwordx4 v9, s[56:57] nt
    s_add_u32 s56, s56, 4096
    s_addc_u32 s57, s57, 0
    s_waitcnt vmcnt(7)
    s_add_u32 m0, s58, 122880
    s_nop 0
    global_load_lds_dwordx4 v10, s[56:57] nt
    s_add_u32 s56, s56, 4096
    s_addc_u32 s57, s57, 0
    s_waitcnt vmcnt(7)
    s_add_u32 m0, s58, 126976
    s_nop 0
    global_load_lds_dwordx4 v11, s[56:57] nt
    s_add_u32 s56, s56, 4096
    s_addc_u32 s57, s57, 0
    s_lshl_b32 s46, s34, 2
    s_lshr_b32 s47, s35, 2
    s_add_u32 s46, s46, s47
    s_lshl_b32 s46, s46, 8
    s_lshl_b32 s47, s40, 20
    s_add_u32 s46, s46, s47
    v_lshrrev_b32 v3, 4, v0
    v_and_b32 v4, 15, v0
    v_lshlrev_b32 v5, 1, v3
    v_xor_b32 v5, v5, v4
    v_xor_b32 v6, 8, v5
    v_lshlrev_b32 v5, 4, v5
    v_lshlrev_b32 v6, 4, v6
    v_lshl_add_u32 v5, v3, 13, v5
    v_lshl_add_u32 v6, v3, 13, v6
    s_waitcnt vmcnt(0)
    s_mov_b64 s[100:101], exec
    s_mov_b64 exec, 1
    ds_add_u32 v61, v62 offset:24
    s_mov_b64 exec, s[100:101]
    s_add_u32 s42, s12, s46
    s_addc_u32 s43, s13, 0
    global_load_dwordx4 v[64:67], v5, s[42:43] nt
    s_add_u32 s42, s42, 32768
    s_addc_u32 s43, s43, 0
    global_load_dwordx4 v[68:71], v6, s[42:43] nt
    s_add_u32 s42, s42, 32768
    s_addc_u32 s43, s43, 0
    global_load_dwordx4 v[72:75], v5, s[42:43] nt
    s_add_u32 s42, s42, 32768
    s_addc_u32 s43, s43, 0
    global_load_dwordx4 v[76:79], v6, s[42:43] nt
    s_add_u32 s42, s42, 32768
    s_addc_u32 s43, s43, 0
    global_load_dwordx4 v[80:83], v5, s[42:43] nt
    s_add_u32 s42, s42, 32768
    s_addc_u32 s43, s43, 0
    global_load_dwordx4 v[84:87], v6, s[42:43] nt
    s_add_u32 s42, s42, 32768
    s_addc_u32 s43, s43, 0
    global_load_dwordx4 v[88:91], v5, s[42:43] nt
    s_add_u32 s42, s42, 32768
    s_addc_u32 s43, s43, 0
    global_load_dwordx4 v[92:95], v6, s[42:43] nt
    s_add_u32 s42, s42, 32768
    s_addc_u32 s43, s43, 0
    global_load_dwordx4 v[96:99], v5, s[42:43] nt
    s_add_u32 s42, s42, 32768
    s_addc_u32 s43, s43, 0
    global_load_dwordx4 v[100:103], v6, s[42:43] nt
    s_add_u32 s42, s42, 32768
    s_addc_u32 s43, s43, 0
    global_load_dwordx4 v[104:107], v5, s[42:43] nt
    s_add_u32 s42, s42, 32768
    s_addc_u32 s43, s43, 0
    global_load_dwordx4 v[108:111], v6, s[42:43] nt
    s_lshl_b32 s47, s40, 15
    v_lshl_add_u32 v12, v0, 4, s47
    s_waitcnt vmcnt(0)
    s_mov_b64 s[100:101], exec
    s_mov_b64 exec, 1
    ds_add_u32 v61, v62 offset:80
    s_mov_b64 exec, s[100:101]
L_lw_1:
    s_sleep 1
    ds_read_b32 v63, v61 offset:44
    s_waitcnt lgkmcnt(0)
    v_readfirstlane_b32 s59, v63
    s_cmp_lt_u32 s59, 4
    s_cbranch_scc1 L_lw_1
    s_add_u32 s46, s46, 393216
    s_add_u32 s42, s12, s46
    s_addc_u32 s43, s13, 0
    global_load_dwordx4 v[112:115], v5, s[42:43] nt
    s_add_u32 s42, s42, 32768
    s_addc_u32 s43, s43, 0
    global_load_dwordx4 v[116:119], v6, s[42:43] nt
    s_add_u32 s42, s42, 32768
    s_addc_u32 s43, s43, 0
    global_load_dwordx4 v[120:123], v5, s[42:43] nt
    s_add_u32 s42, s42, 32768
    s_addc_u32 s43, s43, 0
    global_load_dwordx4 v[124:127], v6, s[42:43] nt
    s_add_u32 s42, s42, 32768
    s_addc_u32 s43, s43, 0
    global_load_dwordx4 v[128:131], v5, s[42:43] nt
    s_add_u32 s42, s42, 32768
    s_addc_u32 s43, s43, 0
    global_load_dwordx4 v[132:135], v6, s[42:43] nt
    s_add_u32 s42, s42, 32768
    s_addc_u32 s43, s43, 0
    global_load_dwordx4 v[136:139], v5, s[42:43] nt
    s_add_u32 s42, s42, 32768
    s_addc_u32 s43, s43, 0
    global_load_dwordx4 v[140:143], v6, s[42:43] nt
    s_add_u32 s42, s42, 32768
    s_addc_u32 s43, s43, 0
    global_load_dwordx4 v[144:147], v5, s[42:43] nt
    s_add_u32 s42, s42, 32768
    s_addc_u32 s43, s43, 0
    global_load_dwordx4 v[148:151], v6, s[42:43] nt
    s_add_u32 s42, s42, 32768
    s_addc_u32 s43, s43, 0
    global_load_dwordx4 v[152:155], v5, s[42:43] nt
    s_add_u32 s42, s42, 32768
    s_addc_u32 s43, s43, 0
    global_load_dwordx4 v[156:159], v6, s[42:43] nt
    s_add_u32 s42, s42, 32768
    s_addc_u32 s43, s43, 0
    global_load_dwordx4 v[160:163], v5, s[42:43] nt
    s_add_u32 s42, s42, 32768
    s_addc_u32 s43, s43, 0
    global_load_dwordx4 v[164:167], v6, s[42:43] nt
    s_add_u32 s42, s42, 32768
    s_addc_u32 s43, s43, 0
    global_load_dwordx4 v[168:171], v5, s[42:43] nt
    s_add_u32 s42, s42, 32768
    s_addc_u32 s43, s43, 0
    global_load_dwordx4 v[172:175], v6, s[42:43] nt
    s_add_u32 s42, s42, 32768
    s_addc_u32 s43, s43, 0
    s_waitcnt vmcnt(15)
    global_load_dwordx4 v[176:179], v5, s[42:43] nt
    s_add_u32 s42, s42, 32768
    s_addc_u32 s43, s43, 0
    s_waitcnt vmcnt(15)
    global_load_dwordx4 v[180:183], v6, s[42:43] nt
    s_add_u32 s42, s42, 32768
    s_addc_u32 s43, s43, 0
    s_waitcnt vmcnt(15)
    global_load_dwordx4 v[184:187], v5, s[42:43] nt
    s_add_u32 s42, s42, 32768
    s_addc_u32 s43, s43, 0
    s_waitcnt vmcnt(15)
    global_load_dwordx4 v[188:191], v6, s[42:43] nt
    s_waitcnt vmcnt(0)
L_lw_2:
    s_sleep 1
    ds_read_b32 v63, v61 offset:36
    s_waitcnt lgkmcnt(0)
    v_readfirstlane_b32 s59, v63
    s_cmp_lt_u32 s59, 4
    s_cbranch_scc1 L_lw_2
    ds_write_b128 v12, v[64:67] offset:0
    ds_write_b128 v12, v[68:71] offset:1024
    ds_write_b128 v12, v[72:75] offset:2048
    ds_write_b128 v12, v[76:79] offset:3072
    ds_write_b128 v12, v[80:83] offset:4096
    ds_write_b128 v12, v[84:87] offset:5120
    ds_write_b128 v12, v[88:91] offset:6144
    ds_write_b128 v12, v[92:95] offset:7168
    ds_write_b128 v12, v[96:99] offset:8192
    ds_write_b128 v12, v[100:103] offset:9216
    ds_write_b128 v12, v[104:107] offset:10240
    ds_write_b128 v12, v[108:111] offset:11264
    ds_write_b128 v12, v[112:115] offset:12288
    ds_write_b128 v12, v[116:119] offset:13312
    ds_write_b128 v12, v[120:123] offset:14336
    ds_write_b128 v12, v[124:127] offset:15360
    ds_write_b128 v12, v[128:131] offset:16384
    ds_write_b128 v12, v[132:135] offset:17408
    ds_write_b128 v12, v[136:139] offset:18432
    ds_write_b128 v12, v[140:143] offset:19456
    ds_write_b128 v12, v[144:147] offset:20480
    ds_write_b128 v12, v[148:151] offset:21504
    ds_write_b128 v12, v[152:155] offset:22528
    ds_write_b128 v12, v[156:159] offset:23552
    ds_write_b128 v12, v[160:163] offset:24576
    ds_write_b128 v12, v[164:167] offset:25600
    ds_write_b128 v12, v[168:171] offset:26624
    ds_write_b128 v12, v[172:175] offset:27648
    ds_write_b128 v12, v[176:179] offset:28672
    ds_write_b128 v12, v[180:183] offset:29696
    ds_write_b128 v12, v[184:187] offset:30720
    ds_write_b128 v12, v[188:191] offset:31744
    s_mov_b64 s[100:101], exec
    s_mov_b64 exec, 1
    ds_add_u32 v61, v62 offset:40
    s_mov_b64 exec, s[100:101]
    s_branch L_fin
L_A_c:
    s_lshr_b32 s42, s34, 1
    s_lshl_b32 s42, s42, 16
    s_add_u32 s42, s42, 262144
    s_lshl_b32 s43, s3, 11
    s_add_u32 s42, s42, s43
    v_lshl_add_u32 v4, v0, 4, s42
    v_lshrrev_b32 v7, 1, v0
    s_lshl_b32 s43, s3, 1
    v_xor_b32 v7, s43, v7
    v_lshlrev_b32 v7, 4, v7
    v_and_b32 v10, 1, v0
    v_lshl_add_u32 v7, v10, 3, v7
    s_lshl_b32 s43, s3, 9
    s_add_u32 s43, s43, 131072
    v_add_u32 v7, s43, v7
    v_xor_b32 v44, 0, v7
    v_xor_b32 v45, 128, v7
    v_xor_b32 v46, 144, v7
    v_xor_b32 v47, 16, v7
    v_mov_b32 v10, v4
    v_add_u32 v11, 8192, v4
    v_add_u32 v12, 16384, v4
    v_add_u32 v13, 24576, v4
    v_add_u32 v14, 32768, v4
    v_add_u32 v15, 40960, v4
    v_add_u32 v16, 49152, v4
    v_add_u32 v17, 57344, v4
    v_and_b32 v4, 3, v1
    v_lshlrev_b32 v4, 1, v4
    v_bfe_u32 v5, v1, 3, 1
    v_bfe_u32 v6, v1, 2, 1
    v_xor_b32 v6, v6, v5
    v_lshlrev_b32 v6, 3, v6
    v_or3_b32 v4, v4, v5, v6
    v_lshrrev_b32 v5, 5, v0
    v_xor_b32 v4, v4, v5
    v_lshlrev_b32 v4, 4, v4
    v_and_b32 v5, 31, v0
    v_lshl_add_u32 v6, v5, 9, v4
    v_add_u32 v6, 131072, v6
    v_lshl_add_u32 v5, v5, 10, v4
    s_lshl_b32 s42, s3, 15
    v_add_u32 v5, s42, v5
    v_xor_b32 v48, 0, v6
    v_xor_b32 v18, 0, v5
    v_xor_b32 v49, 32, v6
    v_xor_b32 v19, 32, v5
    v_xor_b32 v50, 64, v6
    v_xor_b32 v20, 64, v5
    v_xor_b32 v51, 96, v6
    v_xor_b32 v21, 96, v5
    v_xor_b32 v52, 128, v6
    v_xor_b32 v22, 128, v5
    v_xor_b32 v53, 160, v6
    v_xor_b32 v23, 160, v5
    v_xor_b32 v54, 192, v6
    v_xor_b32 v24, 192, v5
    v_xor_b32 v55, 224, v6
    v_xor_b32 v25, 224, v5
    s_waitcnt lgkmcnt(0)
    s_add_u32 s36, s38, 1
    s_not_b32 s37, s36
L_lw_3:
    s_sleep 1
    ds_read_b32 v63, v61 offset:24
    s_waitcnt lgkmcnt(0)
    v_readfirstlane_b32 s59, v63
    s_cmp_lt_u32 s59, 4
    s_cbranch_scc1 L_lw_3
L_lw_4:
    s_sleep 1
    ds_read_b32 v63, v61 offset:80
    s_waitcnt lgkmcnt(0)
    v_readfirstlane_b32 s59, v63
    s_cmp_lt_u32 s59, 4
    s_cbranch_scc1 L_lw_4
    s_lshr_b32 s42, s34, 1
    s_lshl_b32 s42, s42, 16
    s_add_u32 s42, s42, 262144
    v_lshlrev_b32 v26, 8, v3
    v_add_u32 v26, s42, v26
    s_mov_b32 s50, 0
L_poll_5:
    global_load_dwordx4 v[192:195], v10, s[32:33] offset:0 sc1
    global_load_dwordx4 v[196:199], v11, s[32:33] offset:0 sc1
    global_load_dwordx4 v[200:203], v12, s[32:33] offset:0 sc1
    global_load_dwordx4 v[204:207], v13, s[32:33] offset:0 sc1
    global_load_dwordx4 v[208:211], v14, s[32:33] offset:0 sc1
    global_load_dwordx4 v[212:215], v15, s[32:33] offset:0 sc1
    global_load_dwordx4 v[216:219], v16, s[32:33] offset:0 sc1
    global_load_dwordx4 v[220:223], v17, s[32:33] offset:0 sc1
    global_load_dwordx4 v[224:227], v10, s[32:33] offset:1024 sc1
    global_load_dwordx4 v[228:231], v11, s[32:33] offset:1024 sc1
    global_load_dwordx4 v[232:235], v12, s[32:33] offset:1024 sc1
    global_load_dwordx4 v[236:239], v13, s[32:33] offset:1024 sc1
    global_load_dwordx4 v[240:243], v14, s[32:33] offset:1024 sc1
    global_load_dwordx4 v[244:247], v15, s[32:33] offset:1024 sc1
    global_load_dwordx4 v[248:251], v16, s[32:33] offset:1024 sc1
    global_load_dwordx4 v[252:255], v17, s[32:33] offset:1024 sc1
    s_add_u32 s50, s50, 1
    s_waitcnt vmcnt(0)
    v_xor_b32 v58, s36, v194
    v_xor_b32 v59, s37, v195
    v_xor_b32 v57, s36, v198
    v_xor_b32 v56, s37, v199
    v_or3_b32 v58, v58, v57, v56
    v_xor_b32 v57, s36, v202
    v_xor_b32 v56, s37, v203
    v_or3_b32 v58, v58, v57, v56
    v_xor_b32 v57, s36, v206
    v_xor_b32 v56, s37, v207
    v_or3_b32 v58, v58, v57, v56
    v_xor_b32 v57, s36, v210
    v_xor_b32 v56, s37, v211
    v_or3_b32 v58, v58, v57, v56
    v_xor_b32 v57, s36, v214
    v_xor_b32 v56, s37, v215
    v_or3_b32 v58, v58, v57, v56
    v_xor_b32 v57, s36, v218
    v_xor_b32 v56, s37, v219
    v_or3_b32 v58, v58, v57, v56
    v_xor_b32 v57, s36, v222
    v_xor_b32 v56, s37, v223
    v_or3_b32 v58, v58, v57, v56
    v_xor_b32 v57, s36, v226
    v_xor_b32 v56, s37, v227
    v_or3_b32 v58, v58, v57, v56
    v_xor_b32 v57, s36, v230
    v_xor_b32 v56, s37, v231
    v_or3_b32 v58, v58, v57, v56
    v_xor_b32 v57, s36, v234
    v_xor_b32 v56, s37, v235
    v_or3_b32 v58, v58, v57, v56
    v_xor_b32 v57, s36, v238
    v_xor_b32 v56, s37, v239
    v_or3_b32 v58, v58, v57, v56
    v_xor_b32 v57, s36, v242
    v_xor_b32 v56, s37, v243
    v_or3_b32 v58, v58, v57, v56
    v_xor_b32 v57, s36, v246
    v_xor_b32 v56, s37, v247
    v_or3_b32 v58, v58, v57, v56
    v_xor_b32 v57, s36, v250
    v_xor_b32 v56, s37, v251
    v_or3_b32 v58, v58, v57, v56
    v_xor_b32 v57, s36, v254
    v_xor_b32 v56, s37, v255
    v_or3_b32 v58, v58, v57, v56
    v_or_b32 v58, v58, v59
    v_cmp_ne_u32 vcc, 0, v58
    s_cmp_ge_u32 s50, 262144
    s_cbranch_scc1 L_polld_6
    s_cbranch_vccnz L_poll_5
L_polld_6:
    ds_write_b64 v44, v[192:193] offset:0
    ds_write_b64 v45, v[196:197] offset:2048
    ds_write_b64 v46, v[200:201] offset:4096
    ds_write_b64 v47, v[204:205] offset:6144
    ds_write_b64 v44, v[208:209] offset:8192
    ds_write_b64 v45, v[212:213] offset:10240
    ds_write_b64 v46, v[216:217] offset:12288
    ds_write_b64 v47, v[220:221] offset:14336
    s_mov_b64 s[100:101], exec
    s_mov_b64 exec, 1
    ds_add_u32 v61, v62 offset:44
    s_mov_b64 exec, s[100:101]
L_lw_7:
    ds_read_b32 v63, v61 offset:44
    s_waitcnt lgkmcnt(0)
    v_readfirstlane_b32 s59, v63
    s_cmp_lt_u32 s59, 4
    s_cbranch_scc1 L_lw_7
    ds_read_b128 v[64:67], v48 offset:0
    ds_read_b128 v[68:71], v49 offset:0
    ds_read_b128 v[72:75], v50 offset:0
    ds_read_b128 v[76:79], v51 offset:0
    ds_read_b128 v[80:83], v52 offset:0
    ds_read_b128 v[84:87], v53 offset:0
    ds_read_b128 v[88:91], v54 offset:0
    ds_read_b128 v[92:95], v55 offset:0
    ds_read_b128 v[96:99], v48 offset:256
    ds_read_b128 v[100:103], v49 offset:256
    ds_read_b128 v[104:107], v50 offset:256
    ds_read_b128 v[108:111], v51 offset:256
    ds_read_b128 v[112:115], v52 offset:256
    ds_read_b128 v[116:119], v53 offset:256
    ds_read_b128 v[120:123], v54 offset:256
    ds_read_b128 v[124:127], v55 offset:256
    ds_read_b128 v[192:195], v18 offset:0
    ds_read_b128 v[196:199], v19 offset:0
    ds_read_b128 v[200:203], v20 offset:0
    ds_read_b128 v[204:207], v21 offset:0
    ds_read_b128 v[208:211], v22 offset:0
    ds_read_b128 v[212:215], v23 offset:0
    ds_read_b128 v[216:219], v24 offset:0
    ds_read_b128 v[220:223], v25 offset:0
    s_waitcnt lgkmcnt(8)
    s_mov_b64 s[100:101], exec
    s_mov_b64 exec, 1
    ds_add_u32 v61, v62 offset:48
    s_mov_b64 exec, s[100:101]
    s_waitcnt lgkmcnt(7)
    v_mfma_f32_32x32x16_bf16 v[28:43], v[192:195], v[64:67], 0
    ds_read_b128 v[192:195], v18 offset:256
    s_waitcnt lgkmcnt(7)
    v_mfma_f32_32x32x16_bf16 v[28:43], v[196:199], v[68:71], v[28:43]
    ds_read_b128 v[196:199], v19 offset:256
    s_waitcnt lgkmcnt(7)
    v_mfma_f32_32x32x16_bf16 v[28:43], v[200:203], v[72:75], v[28:43]
    ds_read_b128 v[200:203], v20 offset:256
    s_waitcnt lgkmcnt(7)
    v_mfma_f32_32x32x16_bf16 v[28:43], v[204:207], v[76:79], v[28:43]
    ds_read_b128 v[204:207], v21 offset:256
    s_waitcnt lgkmcnt(7)
    v_mfma_f32_32x32x16_bf16 v[28:43], v[208:211], v[80:83], v[28:43]
    ds_read_b128 v[208:211], v22 offset:256
    s_waitcnt lgkmcnt(7)
    v_mfma_f32_32x32x16_bf16 v[28:43], v[212:215], v[84:87], v[28:43]
    ds_read_b128 v[212:215], v23 offset:256
L_lw_8:
    ds_read_b32 v63, v61 offset:48
    s_waitcnt lgkmcnt(0)
    v_readfirstlane_b32 s59, v63
    s_cmp_lt_u32 s59, 4
    s_cbranch_scc1 L_lw_8
    ds_write_b64 v44, v[224:225] offset:0
    ds_write_b64 v45, v[228:229] offset:2048
    ds_write_b64 v46, v[232:233] offset:4096
    ds_write_b64 v47, v[236:237] offset:6144
    ds_write_b64 v44, v[240:241] offset:8192
    ds_write_b64 v45, v[244:245] offset:10240
    ds_write_b64 v46, v[248:249] offset:12288
    ds_write_b64 v47, v[252:253] offset:14336
    s_mov_b64 s[100:101], exec
    s_mov_b64 exec, 1
    ds_add_u32 v61, v62 offset:52
    s_mov_b64 exec, s[100:101]
    s_waitcnt lgkmcnt(7)
    v_mfma_f32_32x32x16_bf16 v[28:43], v[216:219], v[88:91], v[28:43]
    ds_read_b128 v[216:219], v24 offset:256
    s_waitcnt lgkmcnt(7)
    v_mfma_f32_32x32x16_bf16 v[28:43], v[220:223], v[92:95], v[28:43]
    ds_read_b128 v[220:223], v25 offset:256
    s_waitcnt lgkmcnt(7)
    v_mfma_f32_32x32x16_bf16 v[28:43], v[192:195], v[96:99], v[28:43]
    ds_read_b128 v[192:195], v18 offset:512
    s_waitcnt lgkmcnt(6)
    v_mfma_f32_32x32x16_bf16 v[28:43], v[196:199], v[100:103], v[28:43]
    ds_read_b128 v[196:199], v19 offset:512
    s_waitcnt lgkmcnt(5)
    v_mfma_f32_32x32x16_bf16 v[28:43], v[200:203], v[104:107], v[28:43]
    ds_read_b128 v[200:203], v20 offset:512
    s_waitcnt lgkmcnt(4)
    v_mfma_f32_32x32x16_bf16 v[28:43], v[204:207], v[108:111], v[28:43]
    ds_read_b128 v[204:207], v21 offset:512
    s_waitcnt lgkmcnt(3)
    v_mfma_f32_32x32x16_bf16 v[28:43], v[208:211], v[112:115], v[28:43]
    ds_read_b128 v[208:211], v22 offset:512
    s_waitcnt lgkmcnt(2)
    v_mfma_f32_32x32x16_bf16 v[28:43], v[212:215], v[116:119], v[28:43]
    ds_read_b128 v[212:215], v23 offset:512
    s_waitcnt lgkmcnt(1)
    v_mfma_f32_32x32x16_bf16 v[28:43], v[216:219], v[120:123], v[28:43]
    ds_read_b128 v[216:219], v24 offset:512
    s_waitcnt lgkmcnt(0)
    v_mfma_f32_32x32x16_bf16 v[28:43], v[220:223], v[124:127], v[28:43]
    ds_read_b128 v[220:223], v25 offset:512
L_lw_9:
    ds_read_b32 v63, v61 offset:52
    s_waitcnt lgkmcnt(0)
    v_readfirstlane_b32 s59, v63
    s_cmp_lt_u32 s59, 4
    s_cbranch_scc1 L_lw_9
    ds_read_b128 v[128:131], v48 offset:0
    ds_read_b128 v[132:135], v49 offset:0
    ds_read_b128 v[136:139], v50 offset:0
    ds_read_b128 v[140:143], v51 offset:0
    ds_read_b128 v[144:147], v52 offset:0
    ds_read_b128 v[148:151], v53 offset:0
    ds_read_b128 v[152:155], v54 offset:0
    ds_read_b128 v[156:159], v55 offset:0
    ds_read_b128 v[160:163], v48 offset:256
    ds_read_b128 v[164:167], v49 offset:256
    ds_read_b128 v[168:171], v50 offset:256
    ds_read_b128 v[172:175], v51 offset:256
    ds_read_b128 v[176:179], v52 offset:256
    ds_read_b128 v[180:183], v53 offset:256
    ds_read_b128 v[184:187], v54 offset:256
    ds_read_b128 v[188:191], v55 offset:256
    s_waitcnt lgkmcnt(14)
    v_mfma_f32_32x32x16_bf16 v[28:43], v[192:195], v[128:131], v[28:43]
    ds_read_b128 v[192:195], v18 offset:768
    s_waitcnt lgkmcnt(15)
    v_mfma_f32_32x32x16_bf16 v[28:43], v[196:199], v[132:135], v[28:43]
    ds_read_b128 v[196:199], v19 offset:768
    s_waitcnt lgkmcnt(15)
    v_mfma_f32_32x32x16_bf16 v[28:43], v[200:203], v[136:139], v[28:43]
    ds_read_b128 v[200:203], v20 offset:768
    s_waitcnt lgkmcnt(15)
    v_mfma_f32_32x32x16_bf16 v[28:43], v[204:207], v[140:143], v[28:43]
    ds_read_b128 v[204:207], v21 offset:768
    s_waitcnt lgkmcnt(15)
    v_mfma_f32_32x32x16_bf16 v[28:43], v[208:211], v[144:147], v[28:43]
    ds_read_b128 v[208:211], v22 offset:768
    s_waitcnt lgkmcnt(15)
    v_mfma_f32_32x32x16_bf16 v[28:43], v[212:215], v[148:151], v[28:43]
    ds_read_b128 v[212:215], v23 offset:768
    s_waitcnt lgkmcnt(15)
    v_mfma_f32_32x32x16_bf16 v[28:43], v[216:219], v[152:155], v[28:43]
    ds_read_b128 v[216:219], v24 offset:768
    s_waitcnt lgkmcnt(15)
    v_mfma_f32_32x32x16_bf16 v[28:43], v[220:223], v[156:159], v[28:43]
    ds_read_b128 v[220:223], v25 offset:768
    s_waitcnt lgkmcnt(7)
    v_mfma_f32_32x32x16_bf16 v[28:43], v[192:195], v[160:163], v[28:43]
    s_waitcnt lgkmcnt(6)
    v_mfma_f32_32x32x16_bf16 v[28:43], v[196:199], v[164:167], v[28:43]
    s_waitcnt lgkmcnt(5)
    v_mfma_f32_32x32x16_bf16 v[28:43], v[200:203], v[168:171], v[28:43]
    s_waitcnt lgkmcnt(4)
    v_mfma_f32_32x32x16_bf16 v[28:43], v[204:207], v[172:175], v[28:43]
    s_waitcnt lgkmcnt(3)
    v_mfma_f32_32x32x16_bf16 v[28:43], v[208:211], v[176:179], v[28:43]
    s_waitcnt lgkmcnt(2)
    v_mfma_f32_32x32x16_bf16 v[28:43], v[212:215], v[180:183], v[28:43]
    s_waitcnt lgkmcnt(1)
    v_mfma_f32_32x32x16_bf16 v[28:43], v[216:219], v[184:187], v[28:43]
    s_waitcnt lgkmcnt(0)
    v_mfma_f32_32x32x16_bf16 v[28:43], v[220:223], v[188:191], v[28:43]
    v_lshrrev_b32 v4, 2, v1
    v_lshlrev_b32 v5, 1, v4
    v_lshrrev_b32 v6, 1, v2
    v_and_b32 v7, 1, v2
    v_xor_b32 v7, v7, v6
    v_lshlrev_b32 v7, 3, v7
    v_or3_b32 v5, v5, v6, v7
    v_bfe_u32 v6, v1, 1, 1
    v_xor_b32 v5, v5, v6
    v_lshlrev_b32 v5, 4, v5
    v_and_b32 v6, 1, v1
    v_lshlrev_b32 v6, 3, v6
    v_lshl_add_u32 v7, v2, 2, v4
    v_lshlrev_b32 v7, 10, v7
    v_add3_u32 v5, v5, v6, v7
    s_lshl_b32 s42, s3, 8
    v_add_u32 v5, s42, v5
    v_and_b32 v18, 31, v0
    v_lshlrev_b32 v18, 2, v18
    v_add_u32 v18, 155648, v18
    s_lshl_b32 s42, s3, 7
    v_add_u32 v19, s42, v18
    v_lshlrev_b32 v20, 4, v0
    v_add_u32 v20, 147456, v20
    v_bfe_u32 v21, v0, 4, 1
    v_lshlrev_b32 v21, 10, v21
    v_lshrrev_b32 v22, 5, v0
    v_lshl_add_u32 v21, v22, 8, v21
    v_lshl_add_u32 v21, v1, 4, v21
    s_lshl_b32 s42, s3, 11
    s_add_u32 s42, s42, 147456
    v_add_u32 v21, s42, v21
    v_xor_b32 v8, 0, v5
    v_xor_b32 v9, 32, v5
    v_xor_b32 v10, 64, v5
    v_xor_b32 v11, 96, v5
    v_xor_b32 v12, 128, v5
    v_xor_b32 v13, 160, v5
    v_xor_b32 v14, 192, v5
    v_xor_b32 v15, 224, v5
    s_lshr_b32 s42, s34, 1
    s_lshl_b32 s42, s42, 5
    s_and_b32 s43, s34, 1
    s_lshl_b32 s43, s43, 4
    s_add_u32 s43, s43, s35
    s_lshl_b32 s44, s42, 15
    s_lshl_b32 s45, s43, 10
    s_add_u32 s44, s44, s45
    s_lshl_b32 s45, s3, 8
    s_add_u32 s44, s44, s45
    s_add_u32 s44, s44, 1048576
    v_and_b32 v4, 7, v1
    v_lshlrev_b32 v4, 15, v4
    v_lshlrev_b32 v5, 4, v2
    v_add3_u32 v4, v4, v5, s44
    v_lshrrev_b32 v5, 3, v1
    v_lshlrev_b32 v5, 6, v5
    v_xor_b32 v6, 64, v5
    v_add_u32 v6, v6, v4
    v_add_u32 v6, 262144, v6
    v_add_u32 v4, v5, v4
    v_add_u32 v5, 524288, v4
    v_add_u32 v7, 524288, v6
    v_max3_f32 v16, v28, v29, v30
    v_max3_f32 v17, v31, v32, v33
    v_max3_f32 v16, v16, v34, v35
    v_max3_f32 v17, v17, v36, v37
    v_max3_f32 v16, v16, v38, v39
    v_max3_f32 v17, v17, v40, v41
    v_max3_f32 v16, v16, v42, v43
    v_max_f32 v16, v16, v17
    v_mov_b32 v17, v16
    s_nop 1
    v_permlane32_swap_b32 v16, v17
    s_nop 1
    v_max_f32 v16, v16, v17
    ds_write_b32 v19, v16
    s_mov_b64 s[100:101], exec
    s_mov_b64 exec, 1
    ds_add_u32 v61, v62 offset:28
    s_mov_b64 exec, s[100:101]
    v_add_u32 v48, 0x10000, v8
    v_add_u32 v49, 0x10000, v9
    v_add_u32 v50, 0x10000, v10
    v_add_u32 v51, 0x10000, v11
    v_add_u32 v52, 0x10000, v12
    v_add_u32 v53, 0x10000, v13
    v_add_u32 v54, 0x10000, v14
    v_add_u32 v55, 0x10000, v15
    ds_read_b64_tr_b16 v[192:193], v8 offset:0
    ds_read_b64_tr_b16 v[194:195], v8 offset:16384
    ds_read_b64_tr_b16 v[208:209], v9 offset:0
    ds_read_b64_tr_b16 v[210:211], v9 offset:16384
    ds_read_b64_tr_b16 v[196:197], v8 offset:32768
    ds_read_b64_tr_b16 v[198:199], v8 offset:49152
    ds_read_b64_tr_b16 v[212:213], v9 offset:32768
    ds_read_b64_tr_b16 v[214:215], v9 offset:49152
    ds_read_b64_tr_b16 v[200:201], v48 offset:0
    ds_read_b64_tr_b16 v[202:203], v48 offset:16384
    ds_read_b64_tr_b16 v[216:217], v49 offset:0
    ds_read_b64_tr_b16 v[218:219], v49 offset:16384
    ds_read_b64_tr_b16 v[204:205], v48 offset:32768
    ds_read_b64_tr_b16 v[206:207], v48 offset:49152
    ds_read_b64_tr_b16 v[220:221], v49 offset:32768
    ds_read_b64_tr_b16 v[222:223], v49 offset:49152
L_lw_10:
    ds_read_b32 v63, v61 offset:28
    s_waitcnt lgkmcnt(0)
    v_readfirstlane_b32 s59, v63
    s_cmp_lt_u32 s59, 4
    s_cbranch_scc1 L_lw_10
    ds_read_b32 v64, v18 offset:0
    ds_read_b32 v65, v18 offset:128
    ds_read_b32 v66, v18 offset:256
    ds_read_b32 v67, v18 offset:384
    s_waitcnt lgkmcnt(0)
    v_max3_f32 v16, v64, v65, v66
    v_max_f32 v16, v16, v67
    v_sub_f32 v28, v28, v16
    v_sub_f32 v29, v29, v16
    v_sub_f32 v30, v30, v16
    v_sub_f32 v31, v31, v16
    v_sub_f32 v32, v32, v16
    v_sub_f32 v33, v33, v16
    v_sub_f32 v34, v34, v16
    v_sub_f32 v35, v35, v16
    v_sub_f32 v36, v36, v16
    v_sub_f32 v37, v37, v16
    v_sub_f32 v38, v38, v16
    v_sub_f32 v39, v39, v16
    v_sub_f32 v40, v40, v16
    v_sub_f32 v41, v41, v16
    v_sub_f32 v42, v42, v16
    v_sub_f32 v43, v43, v16
    v_exp_f32 v28, v28
    v_exp_f32 v29, v29
    v_exp_f32 v30, v30
    v_exp_f32 v31, v31
    v_exp_f32 v32, v32
    v_exp_f32 v33, v33
    v_exp_f32 v34, v34
    v_exp_f32 v35, v35
    v_exp_f32 v36, v36
    v_exp_f32 v37, v37
    v_exp_f32 v38, v38
    v_exp_f32 v39, v39
    v_exp_f32 v40, v40
    v_exp_f32 v41, v41
    v_exp_f32 v42, v42
    v_exp_f32 v43, v43
    s_nop 0
    v_cvt_pk_bf16_f32 v64, v28, v29
    v_cvt_pk_bf16_f32 v65, v30, v31
    v_cvt_pk_bf16_f32 v66, v36, v37
    v_cvt_pk_bf16_f32 v67, v38, v39
    ds_write_b128 v21, v[64:67] offset:0
    v_cvt_pk_bf16_f32 v68, v32, v33
    v_cvt_pk_bf16_f32 v69, v34, v35
    v_cvt_pk_bf16_f32 v70, v40, v41
    v_cvt_pk_bf16_f32 v71, v42, v43
    ds_write_b128 v21, v[68:71] offset:512
    s_mov_b64 s[100:101], exec
    s_mov_b64 exec, 1
    ds_add_u32 v61, v62 offset:32
    s_mov_b64 exec, s[100:101]
    v_add_f32 v72, v28, v29
    v_add_f32 v73, v30, v31
    v_add_f32 v74, v32, v33
    v_add_f32 v75, v34, v35
    v_add_f32 v76, v36, v37
    v_add_f32 v77, v38, v39
    v_add_f32 v78, v40, v41
    v_add_f32 v79, v42, v43
    v_add_f32 v72, v72, v76
    v_add_f32 v73, v73, v77
    v_add_f32 v74, v74, v78
    v_add_f32 v75, v75, v79
    v_add_f32 v72, v72, v74
    v_add_f32 v73, v73, v75
    v_add_f32 v22, v72, v73
    v_mov_b32 v23, v22
    s_nop 1
    v_permlane32_swap_b32 v22, v23
    s_nop 1
    v_add_f32 v22, v22, v23
    ds_write_b32 v19, v22 offset:512
    s_mov_b64 s[100:101], exec
    s_mov_b64 exec, 1
    ds_add_u32 v61, v62 offset:64
    s_mov_b64 exec, s[100:101]
L_lw_11:
    ds_read_b32 v63, v61 offset:32
    s_waitcnt lgkmcnt(0)
    v_readfirstlane_b32 s59, v63
    s_cmp_lt_u32 s59, 4
    s_cbranch_scc1 L_lw_11
    ds_read_b128 v[64:67], v20 offset:0
    ds_read_b128 v[68:71], v20 offset:1024
    ds_read_b128 v[72:75], v20 offset:2048
    ds_read_b128 v[76:79], v20 offset:3072
    ds_read_b128 v[80:83], v20 offset:4096
    ds_read_b128 v[84:87], v20 offset:5120
    ds_read_b128 v[88:91], v20 offset:6144
    ds_read_b128 v[92:95], v20 offset:7168
    ds_read_b64_tr_b16 v[224:225], v10 offset:0
    ds_read_b64_tr_b16 v[226:227], v10 offset:16384
    ds_read_b64_tr_b16 v[240:241], v11 offset:0
    ds_read_b64_tr_b16 v[242:243], v11 offset:16384
    ds_read_b64_tr_b16 v[228:229], v10 offset:32768
    ds_read_b64_tr_b16 v[230:231], v10 offset:49152
    ds_read_b64_tr_b16 v[244:245], v11 offset:32768
    ds_read_b64_tr_b16 v[246:247], v11 offset:49152
    ds_read_b64_tr_b16 v[232:233], v50 offset:0
    ds_read_b64_tr_b16 v[234:235], v50 offset:16384
    ds_read_b64_tr_b16 v[248:249], v51 offset:0
    ds_read_b64_tr_b16 v[250:251], v51 offset:16384
    ds_read_b64_tr_b16 v[236:237], v50 offset:32768
    ds_read_b64_tr_b16 v[238:239], v50 offset:49152
    ds_read_b64_tr_b16 v[252:253], v51 offset:32768
    ds_read_b64_tr_b16 v[254:255], v51 offset:49152
    s_waitcnt lgkmcnt(15)
    v_mfma_f32_16x16x32_bf16 v[128:131], v[192:195], v[64:67], 0
    v_mfma_f32_16x16x32_bf16 v[132:135], v[192:195], v[68:71], 0
    v_mfma_f32_16x16x32_bf16 v[136:139], v[208:211], v[64:67], 0
    v_mfma_f32_16x16x32_bf16 v[140:143], v[208:211], v[68:71], 0
    s_waitcnt lgkmcnt(15)
    v_mfma_f32_16x16x32_bf16 v[128:131], v[196:199], v[72:75], v[128:131]
    v_mfma_f32_16x16x32_bf16 v[132:135], v[196:199], v[76:79], v[132:135]
    v_mfma_f32_16x16x32_bf16 v[136:139], v[212:215], v[72:75], v[136:139]
    v_mfma_f32_16x16x32_bf16 v[140:143], v[212:215], v[76:79], v[140:143]
    s_waitcnt lgkmcnt(15)
    v_mfma_f32_16x16x32_bf16 v[128:131], v[200:203], v[80:83], v[128:131]
    v_mfma_f32_16x16x32_bf16 v[132:135], v[200:203], v[84:87], v[132:135]
    v_mfma_f32_16x16x32_bf16 v[136:139], v[216:219], v[80:83], v[136:139]
    v_mfma_f32_16x16x32_bf16 v[140:143], v[216:219], v[84:87], v[140:143]
    s_waitcnt lgkmcnt(15)
    v_mfma_f32_16x16x32_bf16 v[128:131], v[204:207], v[88:91], v[128:131]
    v_mfma_f32_16x16x32_bf16 v[132:135], v[204:207], v[92:95], v[132:135]
    v_mfma_f32_16x16x32_bf16 v[136:139], v[220:223], v[88:91], v[136:139]
    v_mfma_f32_16x16x32_bf16 v[140:143], v[220:223], v[92:95], v[140:143]
    ds_read_b64_tr_b16 v[192:193], v12 offset:0
    ds_read_b64_tr_b16 v[194:195], v12 offset:16384
    ds_read_b64_tr_b16 v[208:209], v13 offset:0
    ds_read_b64_tr_b16 v[210:211], v13 offset:16384
    ds_read_b64_tr_b16 v[196:197], v12 offset:32768
    ds_read_b64_tr_b16 v[198:199], v12 offset:49152
    ds_read_b64_tr_b16 v[212:213], v13 offset:32768
    ds_read_b64_tr_b16 v[214:215], v13 offset:49152
    ds_read_b64_tr_b16 v[200:201], v52 offset:0
    ds_read_b64_tr_b16 v[202:203], v52 offset:16384
    ds_read_b64_tr_b16 v[216:217], v53 offset:0
    ds_read_b64_tr_b16 v[218:219], v53 offset:16384
    ds_read_b64_tr_b16 v[204:205], v52 offset:32768
    ds_read_b64_tr_b16 v[206:207], v52 offset:49152
    ds_read_b64_tr_b16 v[220:221], v53 offset:32768
    ds_read_b64_tr_b16 v[222:223], v53 offset:49152
    s_cmp_lg_u32 s3, 0
    s_cbranch_scc1 L_st3_12
L_lw_13:
    ds_read_b32 v63, v61 offset:64
    s_waitcnt lgkmcnt(0)
    v_readfirstlane_b32 s59, v63
    s_cmp_lt_u32 s59, 4
    s_cbranch_scc1 L_lw_13
    ds_read_b32 v28, v18 offset:512
    ds_read_b32 v29, v18 offset:640
    ds_read_b32 v30, v18 offset:768
    ds_read_b32 v31, v18 offset:896
    s_lshl_b32 s44, s42, 8
    s_lshl_b32 s45, s43, 3
    s_add_u32 s44, s44, s45
    s_add_u32 s44, s44, 589824
    v_and_b32 v24, 31, v0
    v_lshl_add_u32 v24, v24, 8, s44
    v_mov_b32 v36, v16
    s_waitcnt lgkmcnt(0)
    v_add_f32 v28, v28, v29
    v_add_f32 v30, v30, v31
    v_add_f32 v37, v28, v30
    s_mov_b64 s[48:49], exec
    s_mov_b64 exec, 0xffffffff
    global_store_dwordx2 v24, v[36:37], s[32:33] sc1
    s_mov_b64 exec, s[48:49]
L_st3_12:
    s_waitcnt lgkmcnt(15)
    v_mfma_f32_16x16x32_bf16 v[144:147], v[224:227], v[64:67], 0
    v_mfma_f32_16x16x32_bf16 v[148:151], v[224:227], v[68:71], 0
    v_mfma_f32_16x16x32_bf16 v[152:155], v[240:243], v[64:67], 0
    v_mfma_f32_16x16x32_bf16 v[156:159], v[240:243], v[68:71], 0
    s_waitcnt lgkmcnt(15)
    v_mfma_f32_16x16x32_bf16 v[144:147], v[228:231], v[72:75], v[144:147]
    v_mfma_f32_16x16x32_bf16 v[148:151], v[228:231], v[76:79], v[148:151]
    v_mfma_f32_16x16x32_bf16 v[152:155], v[244:247], v[72:75], v[152:155]
    v_mfma_f32_16x16x32_bf16 v[156:159], v[244:247], v[76:79], v[156:159]
    s_waitcnt lgkmcnt(15)
    v_mfma_f32_16x16x32_bf16 v[144:147], v[232:235], v[80:83], v[144:147]
    v_mfma_f32_16x16x32_bf16 v[148:151], v[232:235], v[84:87], v[148:151]
    v_mfma_f32_16x16x32_bf16 v[152:155], v[248:251], v[80:83], v[152:155]
    v_mfma_f32_16x16x32_bf16 v[156:159], v[248:251], v[84:87], v[156:159]
    s_waitcnt lgkmcnt(15)
    v_mfma_f32_16x16x32_bf16 v[144:147], v[236:239], v[88:91], v[144:147]
    v_mfma_f32_16x16x32_bf16 v[148:151], v[236:239], v[92:95], v[148:151]
    v_mfma_f32_16x16x32_bf16 v[152:155], v[252:255], v[88:91], v[152:155]
    v_mfma_f32_16x16x32_bf16 v[156:159], v[252:255], v[92:95], v[156:159]
    ds_read_b64_tr_b16 v[224:225], v14 offset:0
    ds_read_b64_tr_b16 v[226:227], v14 offset:16384
    ds_read_b64_tr_b16 v[240:241], v15 offset:0
    ds_read_b64_tr_b16 v[242:243], v15 offset:16384
    ds_read_b64_tr_b16 v[228:229], v14 offset:32768
    ds_read_b64_tr_b16 v[230:231], v14 offset:49152
    ds_read_b64_tr_b16 v[244:245], v15 offset:32768
    ds_read_b64_tr_b16 v[246:247], v15 offset:49152
    ds_read_b64_tr_b16 v[232:233], v54 offset:0
    ds_read_b64_tr_b16 v[234:235], v54 offset:16384
    ds_read_b64_tr_b16 v[248:249], v55 offset:0
    ds_read_b64_tr_b16 v[250:251], v55 offset:16384
    ds_read_b64_tr_b16 v[236:237], v54 offset:32768
    ds_read_b64_tr_b16 v[238:239], v54 offset:49152
    ds_read_b64_tr_b16 v[252:253], v55 offset:32768
    ds_read_b64_tr_b16 v[254:255], v55 offset:49152
    s_waitcnt lgkmcnt(15)
    v_mfma_f32_16x16x32_bf16 v[160:163], v[192:195], v[64:67], 0
    v_mfma_f32_16x16x32_bf16 v[164:167], v[192:195], v[68:71], 0
    v_mfma_f32_16x16x32_bf16 v[168:171], v[208:211], v[64:67], 0
    v_mfma_f32_16x16x32_bf16 v[172:175], v[208:211], v[68:71], 0
    s_waitcnt lgkmcnt(15)
    v_mfma_f32_16x16x32_bf16 v[160:163], v[196:199], v[72:75], v[160:163]
    v_mfma_f32_16x16x32_bf16 v[164:167], v[196:199], v[76:79], v[164:167]
    v_mfma_f32_16x16x32_bf16 v[168:171], v[212:215], v[72:75], v[168:171]
    v_mfma_f32_16x16x32_bf16 v[172:175], v[212:215], v[76:79], v[172:175]
    v_cvt_pk_bf16_f32 v96, v128, v129
    v_cvt_pk_bf16_f32 v97, v130, v131
    v_cvt_pk_bf16_f32 v98, v136, v137
    v_cvt_pk_bf16_f32 v99, v138, v139
    v_cvt_pk_bf16_f32 v104, v144, v145
    v_cvt_pk_bf16_f32 v105, v146, v147
    v_cvt_pk_bf16_f32 v106, v152, v153
    v_cvt_pk_bf16_f32 v107, v154, v155
    v_mov_b32 v100, v96
    v_mov_b32 v101, v97
    v_mov_b32 v102, v98
    v_mov_b32 v103, v99
    v_mov_b32_dpp v96, v104 row_ror:8 row_mask:0xf bank_mask:0xc
    v_mov_b32_dpp v97, v105 row_ror:8 row_mask:0xf bank_mask:0xc
    v_mov_b32_dpp v98, v106 row_ror:8 row_mask:0xf bank_mask:0xc
    v_mov_b32_dpp v99, v107 row_ror:8 row_mask:0xf bank_mask:0xc
    v_mov_b32_dpp v100, v104 row_ror:8 row_mask:0xf bank_mask:0x3
    v_mov_b32_dpp v101, v105 row_ror:8 row_mask:0xf bank_mask:0x3
    v_mov_b32_dpp v102, v106 row_ror:8 row_mask:0xf bank_mask:0x3
    v_mov_b32_dpp v103, v107 row_ror:8 row_mask:0xf bank_mask:0x3
    global_store_dwordx4 v4, v[96:99], s[32:33] offset:0 sc1
    global_store_dwordx4 v6, v[100:103], s[32:33] offset:0 sc1
    v_cvt_pk_bf16_f32 v108, v132, v133
    v_cvt_pk_bf16_f32 v109, v134, v135
    v_cvt_pk_bf16_f32 v110, v140, v141
    v_cvt_pk_bf16_f32 v111, v142, v143
    v_cvt_pk_bf16_f32 v116, v148, v149
    v_cvt_pk_bf16_f32 v117, v150, v151
    v_cvt_pk_bf16_f32 v118, v156, v157
    v_cvt_pk_bf16_f32 v119, v158, v159
    v_mov_b32 v112, v108
    v_mov_b32 v113, v109
    v_mov_b32 v114, v110
    v_mov_b32 v115, v111
    v_mov_b32_dpp v108, v116 row_ror:8 row_mask:0xf bank_mask:0xc
    v_mov_b32_dpp v109, v117 row_ror:8 row_mask:0xf bank_mask:0xc
    v_mov_b32_dpp v110, v118 row_ror:8 row_mask:0xf bank_mask:0xc
    v_mov_b32_dpp v111, v119 row_ror:8 row_mask:0xf bank_mask:0xc
    v_mov_b32_dpp v112, v116 row_ror:8 row_mask:0xf bank_mask:0x3
    v_mov_b32_dpp v113, v117 row_ror:8 row_mask:0xf bank_mask:0x3
    v_mov_b32_dpp v114, v118 row_ror:8 row_mask:0xf bank_mask:0x3
    v_mov_b32_dpp v115, v119 row_ror:8 row_mask:0xf bank_mask:0x3
    global_store_dwordx4 v5, v[108:111], s[32:33] offset:0 sc1
    global_store_dwordx4 v7, v[112:115], s[32:33] offset:0 sc1
    s_waitcnt lgkmcnt(15)
    v_mfma_f32_16x16x32_bf16 v[160:163], v[200:203], v[80:83], v[160:163]
    v_mfma_f32_16x16x32_bf16 v[164:167], v[200:203], v[84:87], v[164:167]
    v_mfma_f32_16x16x32_bf16 v[168:171], v[216:219], v[80:83], v[168:171]
    v_mfma_f32_16x16x32_bf16 v[172:175], v[216:219], v[84:87], v[172:175]
    s_waitcnt lgkmcnt(15)
    v_mfma_f32_16x16x32_bf16 v[160:163], v[204:207], v[88:91], v[160:163]
    v_mfma_f32_16x16x32_bf16 v[164:167], v[204:207], v[92:95], v[164:167]
    v_mfma_f32_16x16x32_bf16 v[168:171], v[220:223], v[88:91], v[168:171]
    v_mfma_f32_16x16x32_bf16 v[172:175], v[220:223], v[92:95], v[172:175]
    s_waitcnt lgkmcnt(12)
    v_mfma_f32_16x16x32_bf16 v[176:179], v[224:227], v[64:67], 0
    v_mfma_f32_16x16x32_bf16 v[180:183], v[224:227], v[68:71], 0
    v_mfma_f32_16x16x32_bf16 v[184:187], v[240:243], v[64:67], 0
    v_mfma_f32_16x16x32_bf16 v[188:191], v[240:243], v[68:71], 0
    s_waitcnt lgkmcnt(8)
    v_mfma_f32_16x16x32_bf16 v[176:179], v[228:231], v[72:75], v[176:179]
    v_mfma_f32_16x16x32_bf16 v[180:183], v[228:231], v[76:79], v[180:183]
    v_mfma_f32_16x16x32_bf16 v[184:187], v[244:247], v[72:75], v[184:187]
    v_mfma_f32_16x16x32_bf16 v[188:191], v[244:247], v[76:79], v[188:191]
    s_waitcnt lgkmcnt(4)
    v_mfma_f32_16x16x32_bf16 v[176:179], v[232:235], v[80:83], v[176:179]
    v_mfma_f32_16x16x32_bf16 v[180:183], v[232:235], v[84:87], v[180:183]
    v_mfma_f32_16x16x32_bf16 v[184:187], v[248:251], v[80:83], v[184:187]
    v_mfma_f32_16x16x32_bf16 v[188:191], v[248:251], v[84:87], v[188:191]
    s_waitcnt lgkmcnt(0)
    v_mfma_f32_16x16x32_bf16 v[176:179], v[236:239], v[88:91], v[176:179]
    v_mfma_f32_16x16x32_bf16 v[180:183], v[236:239], v[92:95], v[180:183]
    v_mfma_f32_16x16x32_bf16 v[184:187], v[252:255], v[88:91], v[184:187]
    v_mfma_f32_16x16x32_bf16 v[188:191], v[252:255], v[92:95], v[188:191]
    s_mov_b64 s[100:101], exec
    s_mov_b64 exec, 1
    ds_add_u32 v61, v62 offset:36
    s_mov_b64 exec, s[100:101]
    s_add_u32 s44, s42, s43
    s_lshl_b32 s44, s44, 7
    s_lshl_b32 s45, s3, 2
    s_add_u32 s44, s44, s45
    s_add_u32 s44, s44, 524288
    v_mov_b32 v24, s44
    v_mov_b32 v25, s36
    v_cvt_pk_bf16_f32 v96, v160, v161
    v_cvt_pk_bf16_f32 v97, v162, v163
    v_cvt_pk_bf16_f32 v98, v168, v169
    v_cvt_pk_bf16_f32 v99, v170, v171
    v_cvt_pk_bf16_f32 v104, v176, v177
    v_cvt_pk_bf16_f32 v105, v178, v179
    v_cvt_pk_bf16_f32 v106, v184, v185
    v_cvt_pk_bf16_f32 v107, v186, v187
    v_mov_b32 v100, v96
    v_mov_b32 v101, v97
    v_mov_b32 v102, v98
    v_mov_b32 v103, v99
    v_mov_b32_dpp v96, v104 row_ror:8 row_mask:0xf bank_mask:0xc
    v_mov_b32_dpp v97, v105 row_ror:8 row_mask:0xf bank_mask:0xc
    v_mov_b32_dpp v98, v106 row_ror:8 row_mask:0xf bank_mask:0xc
    v_mov_b32_dpp v99, v107 row_ror:8 row_mask:0xf bank_mask:0xc
    v_mov_b32_dpp v100, v104 row_ror:8 row_mask:0xf bank_mask:0x3
    v_mov_b32_dpp v101, v105 row_ror:8 row_mask:0xf bank_mask:0x3
    v_mov_b32_dpp v102, v106 row_ror:8 row_mask:0xf bank_mask:0x3
    v_mov_b32_dpp v103, v107 row_ror:8 row_mask:0xf bank_mask:0x3
    global_store_dwordx4 v4, v[96:99], s[32:33] offset:128 sc1
    global_store_dwordx4 v6, v[100:103], s[32:33] offset:128 sc1
    v_cvt_pk_bf16_f32 v108, v164, v165
    v_cvt_pk_bf16_f32 v109, v166, v167
    v_cvt_pk_bf16_f32 v110, v172, v173
    v_cvt_pk_bf16_f32 v111, v174, v175
    v_cvt_pk_bf16_f32 v116, v180, v181
    v_cvt_pk_bf16_f32 v117, v182, v183
    v_cvt_pk_bf16_f32 v118, v188, v189
    v_cvt_pk_bf16_f32 v119, v190, v191
    v_mov_b32 v112, v108
    v_mov_b32 v113, v109
    v_mov_b32 v114, v110
    v_mov_b32 v115, v111
    v_mov_b32_dpp v108, v116 row_ror:8 row_mask:0xf bank_mask:0xc
    v_mov_b32_dpp v109, v117 row_ror:8 row_mask:0xf bank_mask:0xc
    v_mov_b32_dpp v110, v118 row_ror:8 row_mask:0xf bank_mask:0xc
    v_mov_b32_dpp v111, v119 row_ror:8 row_mask:0xf bank_mask:0xc
    v_mov_b32_dpp v112, v116 row_ror:8 row_mask:0xf bank_mask:0x3
    v_mov_b32_dpp v113, v117 row_ror:8 row_mask:0xf bank_mask:0x3
    v_mov_b32_dpp v114, v118 row_ror:8 row_mask:0xf bank_mask:0x3
    v_mov_b32_dpp v115, v119 row_ror:8 row_mask:0xf bank_mask:0x3
    global_store_dwordx4 v5, v[108:111], s[32:33] offset:128 sc1
    global_store_dwordx4 v7, v[112:115], s[32:33] offset:128 sc1
    s_waitcnt vmcnt(0)
    s_mov_b64 s[48:49], exec
    s_mov_b64 exec, 1
    global_store_dword v24, v25, s[32:33] sc1
    s_mov_b64 exec, s[48:49]
    s_lshl_b32 s54, s34, 2
    s_lshr_b32 s47, s35, 2
    s_add_u32 s54, s54, s47
    s_and_b32 s55, s35, 3
    s_lshl_b32 s42, s55, 12
    s_add_u32 s42, s42, 524288
    v_and_b32 v4, 31, v0
    v_lshl_add_u32 v5, v4, 7, s42
    s_lshl_b32 s42, s55, 5
    s_add_u32 s42, s42, s54
    s_lshl_b32 s43, s42, 8
    s_add_u32 s43, s43, 589824
    v_lshl_add_u32 v6, v4, 3, s43
    s_lshl_b32 s43, s42, 15
    s_lshl_b32 s44, s3, 13
    s_add_u32 s43, s43, s44
    s_add_u32 s43, s43, 1048576
    v_lshl_add_u32 v7, v0, 4, s43
    v_add_u32 v10, 4096, v7
    v_lshlrev_b32 v4, 5, v0
    v_add_u32 v4, 131072, v4
    s_lshl_b32 s42, s3, 11
    v_add_u32 v11, s42, v4
    v_lshrrev_b32 v12, 2, v1
    v_lshl_add_u32 v12, v2, 2, v12
    v_and_b32 v13, 7, v12
    v_lshlrev_b32 v13, 1, v13
    v_bfe_u32 v14, v1, 1, 1
    v_xor_b32 v13, v13, v14
    v_lshlrev_b32 v13, 4, v13
    v_and_b32 v14, 1, v1
    v_lshlrev_b32 v14, 3, v14
    v_lshlrev_b32 v12, 8, v12
    v_add3_u32 v12, v12, v13, v14
    s_lshl_b32 s42, s3, 6
    v_xor_b32 v12, s42, v12
    v_xor_b32 v13, 32, v12
    v_add_u32 v14, 0x10000, v12
    v_add_u32 v15, 0x10000, v13
L_lw_14:
    ds_read_b32 v63, v61 offset:40
    s_waitcnt lgkmcnt(0)
    v_readfirstlane_b32 s59, v63
    s_cmp_lt_u32 s59, 4
    s_cbranch_scc1 L_lw_14
    ds_read_b64_tr_b16 v[128:129], v12 offset:0
    ds_read_b64_tr_b16 v[130:131], v12 offset:4096
    ds_read_b64_tr_b16 v[132:133], v13 offset:0
    ds_read_b64_tr_b16 v[134:135], v13 offset:4096
    ds_read_b64_tr_b16 v[136:137], v12 offset:8192
    ds_read_b64_tr_b16 v[138:139], v12 offset:12288
    ds_read_b64_tr_b16 v[140:141], v13 offset:8192
    ds_read_b64_tr_b16 v[142:143], v13 offset:12288
    ds_read_b64_tr_b16 v[144:145], v12 offset:16384
    ds_read_b64_tr_b16 v[146:147], v12 offset:20480
    ds_read_b64_tr_b16 v[148:149], v13 offset:16384
    ds_read_b64_tr_b16 v[150:151], v13 offset:20480
    ds_read_b64_tr_b16 v[152:153], v12 offset:24576
    ds_read_b64_tr_b16 v[154:155], v12 offset:28672
    ds_read_b64_tr_b16 v[156:157], v13 offset:24576
    ds_read_b64_tr_b16 v[158:159], v13 offset:28672
    ds_read_b64_tr_b16 v[160:161], v12 offset:32768
    ds_read_b64_tr_b16 v[162:163], v12 offset:36864
    ds_read_b64_tr_b16 v[164:165], v13 offset:32768
    ds_read_b64_tr_b16 v[166:167], v13 offset:36864
    ds_read_b64_tr_b16 v[168:169], v12 offset:40960
    ds_read_b64_tr_b16 v[170:171], v12 offset:45056
    ds_read_b64_tr_b16 v[172:173], v13 offset:40960
    ds_read_b64_tr_b16 v[174:175], v13 offset:45056
    ds_read_b64_tr_b16 v[176:177], v12 offset:49152
    ds_read_b64_tr_b16 v[178:179], v12 offset:53248
    ds_read_b64_tr_b16 v[180:181], v13 offset:49152
    ds_read_b64_tr_b16 v[182:183], v13 offset:53248
    ds_read_b64_tr_b16 v[184:185], v12 offset:57344
    ds_read_b64_tr_b16 v[186:187], v12 offset:61440
    ds_read_b64_tr_b16 v[188:189], v13 offset:57344
    ds_read_b64_tr_b16 v[190:191], v13 offset:61440
    ds_read_b64_tr_b16 v[192:193], v14 offset:0
    ds_read_b64_tr_b16 v[194:195], v14 offset:4096
    ds_read_b64_tr_b16 v[196:197], v15 offset:0
    ds_read_b64_tr_b16 v[198:199], v15 offset:4096
    ds_read_b64_tr_b16 v[200:201], v14 offset:8192
    ds_read_b64_tr_b16 v[202:203], v14 offset:12288
    ds_read_b64_tr_b16 v[204:205], v15 offset:8192
    ds_read_b64_tr_b16 v[206:207], v15 offset:12288
    ds_read_b64_tr_b16 v[208:209], v14 offset:16384
    ds_read_b64_tr_b16 v[210:211], v14 offset:20480
    ds_read_b64_tr_b16 v[212:213], v15 offset:16384
    ds_read_b64_tr_b16 v[214:215], v15 offset:20480
    ds_read_b64_tr_b16 v[216:217], v14 offset:24576
    ds_read_b64_tr_b16 v[218:219], v14 offset:28672
    ds_read_b64_tr_b16 v[220:221], v15 offset:24576
    ds_read_b64_tr_b16 v[222:223], v15 offset:28672
    ds_read_b64_tr_b16 v[224:225], v14 offset:32768
    ds_read_b64_tr_b16 v[226:227], v14 offset:36864
    ds_read_b64_tr_b16 v[228:229], v15 offset:32768
    ds_read_b64_tr_b16 v[230:231], v15 offset:36864
    ds_read_b64_tr_b16 v[232:233], v14 offset:40960
    ds_read_b64_tr_b16 v[234:235], v14 offset:45056
    ds_read_b64_tr_b16 v[236:237], v15 offset:40960
    ds_read_b64_tr_b16 v[238:239], v15 offset:45056
    ds_read_b64_tr_b16 v[240:241], v14 offset:49152
    ds_read_b64_tr_b16 v[242:243], v14 offset:53248
    ds_read_b64_tr_b16 v[244:245], v15 offset:49152
    ds_read_b64_tr_b16 v[246:247], v15 offset:53248
    ds_read_b64_tr_b16 v[248:249], v14 offset:57344
    ds_read_b64_tr_b16 v[250:251], v14 offset:61440
    ds_read_b64_tr_b16 v[252:253], v15 offset:57344
    ds_read_b64_tr_b16 v[254:255], v15 offset:61440
    s_waitcnt lgkmcnt(0)
    s_cmp_lg_u32 s3, 0
    s_cbranch_scc1 L_f3w_15
    s_mov_b32 s50, 0
L_poll_16:
    global_load_dwordx4 v[96:99], v5, s[32:33] sc1
    s_add_u32 s50, s50, 1
    s_waitcnt vmcnt(0)
    v_xor_b32 v58, s36, v96
    v_mov_b32 v59, 0
    v_xor_b32 v57, s36, v97
    v_or_b32 v58, v58, v57
    v_xor_b32 v57, s36, v98
    v_or_b32 v58, v58, v57
    v_xor_b32 v57, s36, v99
    v_or_b32 v58, v58, v57
    v_or_b32 v58, v58, v59
    v_cmp_ne_u32 vcc, 0, v58
    s_cmp_ge_u32 s50, 262144
    s_cbranch_scc1 L_polld_17
    s_cbranch_vccnz L_poll_16
L_polld_17:
    s_mov_b64 s[100:101], exec
    s_mov_b64 exec, 1
    ds_add_u32 v61, v62 offset:84
    s_mov_b64 exec, s[100:101]
L_f3w_15:
L_lw_18:
    ds_read_b32 v63, v61 offset:84
    s_waitcnt lgkmcnt(0)
    v_readfirstlane_b32 s59, v63
    s_cmp_lt_u32 s59, 1
    s_cbranch_scc1 L_lw_18
    global_load_dwordx2 v[16:17], v6, s[32:33] sc1
    global_load_dwordx4 v[64:67], v7, s[32:33] offset:0 sc1
    global_load_dwordx4 v[68:71], v7, s[32:33] offset:1024 sc1
    global_load_dwordx4 v[72:75], v7, s[32:33] offset:2048 sc1
    global_load_dwordx4 v[76:79], v7, s[32:33] offset:3072 sc1
    global_load_dwordx4 v[80:83], v10, s[32:33] offset:0 sc1
    global_load_dwordx4 v[84:87], v10, s[32:33] offset:1024 sc1
    global_load_dwordx4 v[88:91], v10, s[32:33] offset:2048 sc1
    global_load_dwordx4 v[92:95], v10, s[32:33] offset:3072 sc1
    s_waitcnt vmcnt(8)
    v_mov_b32 v18, v16
    s_nop 1
    v_max_f32_dpp v18, v18, v18 quad_perm:[1,0,3,2] row_mask:0xf bank_mask:0xf
    s_nop 1
    v_max_f32_dpp v18, v18, v18 quad_perm:[2,3,0,1] row_mask:0xf bank_mask:0xf
    s_nop 1
    v_max_f32_dpp v18, v18, v18 row_half_mirror row_mask:0xf bank_mask:0xf
    s_nop 1
    v_max_f32_dpp v18, v18, v18 row_mirror row_mask:0xf bank_mask:0xf
    s_nop 0
    v_mov_b32 v19, v18
    s_nop 1
    v_permlane16_swap_b32 v18, v19
    s_nop 1
    v_max_f32 v18, v18, v19
    v_mov_b32 v19, v18
    s_nop 1
    v_permlane32_swap_b32 v18, v19
    s_nop 1
    v_max_f32 v18, v18, v19
    v_sub_f32 v16, v16, v18
    v_exp_f32 v16, v16
    s_nop 0
    v_mul_f32 v17, v17, v16
    s_nop 1
    v_add_f32_dpp v17, v17, v17 quad_perm:[1,0,3,2] row_mask:0xf bank_mask:0xf
    s_nop 1
    v_add_f32_dpp v17, v17, v17 quad_perm:[2,3,0,1] row_mask:0xf bank_mask:0xf
    s_nop 1
    v_add_f32_dpp v17, v17, v17 row_half_mirror row_mask:0xf bank_mask:0xf
    s_nop 1
    v_add_f32_dpp v17, v17, v17 row_mirror row_mask:0xf bank_mask:0xf
    s_nop 0
    v_mov_b32 v19, v17
    s_nop 1
    v_permlane16_swap_b32 v17, v19
    s_nop 1
    v_add_f32 v17, v17, v19
    v_mov_b32 v19, v17
    s_nop 1
    v_permlane32_swap_b32 v17, v19
    s_nop 1
    v_add_f32 v17, v17, v19
    v_rcp_f32 v17, v17
    s_nop 0
    v_mul_f32 v16, v16, v17
    v_add_f32 v16, v16, v16
    s_lshl_b32 s42, s3, 3
    s_nop 0
    s_add_u32 s43, s42, 0
    v_readlane_b32 s92, v16, s43
    s_add_u32 s43, s42, 1
    v_readlane_b32 s93, v16, s43
    s_add_u32 s43, s42, 2
    v_readlane_b32 s94, v16, s43
    s_add_u32 s43, s42, 3
    v_readlane_b32 s95, v16, s43
    s_add_u32 s43, s42, 4
    v_readlane_b32 s96, v16, s43
    s_add_u32 s43, s42, 5
    v_readlane_b32 s97, v16, s43
    s_add_u32 s43, s42, 6
    v_readlane_b32 s98, v16, s43
    s_add_u32 s43, s42, 7
    v_readlane_b32 s99, v16, s43
    s_waitcnt vmcnt(7)
    v_lshlrev_b32 v20, 16, v64
    v_and_b32 v21, 0xffff0000, v64
    v_mul_f32 v32, s92, v20
    v_mul_f32 v33, s92, v21
    v_lshlrev_b32 v20, 16, v65
    v_and_b32 v21, 0xffff0000, v65
    v_mul_f32 v34, s92, v20
    v_mul_f32 v35, s92, v21
    v_lshlrev_b32 v20, 16, v66
    v_and_b32 v21, 0xffff0000, v66
    v_mul_f32 v36, s92, v20
    v_mul_f32 v37, s92, v21
    v_lshlrev_b32 v20, 16, v67
    v_and_b32 v21, 0xffff0000, v67
    v_mul_f32 v38, s92, v20
    v_mul_f32 v39, s92, v21
    s_waitcnt vmcnt(6)
    v_lshlrev_b32 v20, 16, v68
    v_and_b32 v21, 0xffff0000, v68
    v_fmac_f32 v32, s93, v20
    v_fmac_f32 v33, s93, v21
    v_lshlrev_b32 v20, 16, v69
    v_and_b32 v21, 0xffff0000, v69
    v_fmac_f32 v34, s93, v20
    v_fmac_f32 v35, s93, v21
    v_lshlrev_b32 v20, 16, v70
    v_and_b32 v21, 0xffff0000, v70
    v_fmac_f32 v36, s93, v20
    v_fmac_f32 v37, s93, v21
    v_lshlrev_b32 v20, 16, v71
    v_and_b32 v21, 0xffff0000, v71
    v_fmac_f32 v38, s93, v20
    v_fmac_f32 v39, s93, v21
    s_waitcnt vmcnt(5)
    v_lshlrev_b32 v20, 16, v72
    v_and_b32 v21, 0xffff0000, v72
    v_fmac_f32 v32, s94, v20
    v_fmac_f32 v33, s94, v21
    v_lshlrev_b32 v20, 16, v73
    v_and_b32 v21, 0xffff0000, v73
    v_fmac_f32 v34, s94, v20
    v_fmac_f32 v35, s94, v21
    v_lshlrev_b32 v20, 16, v74
    v_and_b32 v21, 0xffff0000, v74
    v_fmac_f32 v36, s94, v20
    v_fmac_f32 v37, s94, v21
    v_lshlrev_b32 v20, 16, v75
    v_and_b32 v21, 0xffff0000, v75
    v_fmac_f32 v38, s94, v20
    v_fmac_f32 v39, s94, v21
    s_waitcnt vmcnt(4)
    v_lshlrev_b32 v20, 16, v76
    v_and_b32 v21, 0xffff0000, v76
    v_fmac_f32 v32, s95, v20
    v_fmac_f32 v33, s95, v21
    v_lshlrev_b32 v20, 16, v77
    v_and_b32 v21, 0xffff0000, v77
    v_fmac_f32 v34, s95, v20
    v_fmac_f32 v35, s95, v21
    v_lshlrev_b32 v20, 16, v78
    v_and_b32 v21, 0xffff0000, v78
    v_fmac_f32 v36, s95, v20
    v_fmac_f32 v37, s95, v21
    v_lshlrev_b32 v20, 16, v79
    v_and_b32 v21, 0xffff0000, v79
    v_fmac_f32 v38, s95, v20
    v_fmac_f32 v39, s95, v21
    s_waitcnt vmcnt(3)
    v_lshlrev_b32 v20, 16, v80
    v_and_b32 v21, 0xffff0000, v80
    v_fmac_f32 v32, s96, v20
    v_fmac_f32 v33, s96, v21
    v_lshlrev_b32 v20, 16, v81
    v_and_b32 v21, 0xffff0000, v81
    v_fmac_f32 v34, s96, v20
    v_fmac_f32 v35, s96, v21
    v_lshlrev_b32 v20, 16, v82
    v_and_b32 v21, 0xffff0000, v82
    v_fmac_f32 v36, s96, v20
    v_fmac_f32 v37, s96, v21
    v_lshlrev_b32 v20, 16, v83
    v_and_b32 v21, 0xffff0000, v83
    v_fmac_f32 v38, s96, v20
    v_fmac_f32 v39, s96, v21
    s_waitcnt vmcnt(2)
    v_lshlrev_b32 v20, 16, v84
    v_and_b32 v21, 0xffff0000, v84
    v_fmac_f32 v32, s97, v20
    v_fmac_f32 v33, s97, v21
    v_lshlrev_b32 v20, 16, v85
    v_and_b32 v21, 0xffff0000, v85
    v_fmac_f32 v34, s97, v20
    v_fmac_f32 v35, s97, v21
    v_lshlrev_b32 v20, 16, v86
    v_and_b32 v21, 0xffff0000, v86
    v_fmac_f32 v36, s97, v20
    v_fmac_f32 v37, s97, v21
    v_lshlrev_b32 v20, 16, v87
    v_and_b32 v21, 0xffff0000, v87
    v_fmac_f32 v38, s97, v20
    v_fmac_f32 v39, s97, v21
    s_waitcnt vmcnt(1)
    v_lshlrev_b32 v20, 16, v88
    v_and_b32 v21, 0xffff0000, v88
    v_fmac_f32 v32, s98, v20
    v_fmac_f32 v33, s98, v21
    v_lshlrev_b32 v20, 16, v89
    v_and_b32 v21, 0xffff0000, v89
    v_fmac_f32 v34, s98, v20
    v_fmac_f32 v35, s98, v21
    v_lshlrev_b32 v20, 16, v90
    v_and_b32 v21, 0xffff0000, v90
    v_fmac_f32 v36, s98, v20
    v_fmac_f32 v37, s98, v21
    v_lshlrev_b32 v20, 16, v91
    v_and_b32 v21, 0xffff0000, v91
    v_fmac_f32 v38, s98, v20
    v_fmac_f32 v39, s98, v21
    s_waitcnt vmcnt(0)
    v_lshlrev_b32 v20, 16, v92
    v_and_b32 v21, 0xffff0000, v92
    v_fmac_f32 v32, s99, v20
    v_fmac_f32 v33, s99, v21
    v_lshlrev_b32 v20, 16, v93
    v_and_b32 v21, 0xffff0000, v93
    v_fmac_f32 v34, s99, v20
    v_fmac_f32 v35, s99, v21
    v_lshlrev_b32 v20, 16, v94
    v_and_b32 v21, 0xffff0000, v94
    v_fmac_f32 v36, s99, v20
    v_fmac_f32 v37, s99, v21
    v_lshlrev_b32 v20, 16, v95
    v_and_b32 v21, 0xffff0000, v95
    v_fmac_f32 v38, s99, v20
    v_fmac_f32 v39, s99, v21
    ds_write_b128 v11, v[32:35]
    ds_write_b128 v11, v[36:39] offset:16
    s_mov_b64 s[100:101], exec
    s_mov_b64 exec, 1
    ds_add_u32 v61, v62 offset:68
    s_mov_b64 exec, s[100:101]
    s_lshl_b32 s42, s3, 10
    s_add_u32 s42, s42, 147456
    v_lshl_add_u32 v5, v0, 4, s42
    v_lshl_add_u32 v6, v2, 4, s42
    s_lshl_b32 s42, s55, 14
    s_lshl_b32 s43, s54, 9
    s_add_u32 s42, s42, s43
    s_lshl_b32 s43, s3, 7
    s_add_u32 s42, s42, s43
    s_add_u32 s42, s42, 8388608
    v_lshlrev_b32 v14, 6, v1
    v_lshl_add_u32 v14, v2, 4, v14
    v_add_u32 v14, s42, v14
    v_mov_b32 v38, s36
    v_mov_b32 v39, s37
    v_cmp_gt_u32 vcc, 2, v1
    v_cmp_eq_u32 s[52:53], 1, v1
L_lw_19:
    ds_read_b32 v63, v61 offset:68
    s_waitcnt lgkmcnt(0)
    v_readfirstlane_b32 s59, v63
    s_cmp_lt_u32 s59, 4
    s_cbranch_scc1 L_lw_19
    ds_read_b128 v[64:67], v4 offset:0
    ds_read_b128 v[68:71], v4 offset:16
    ds_read_b128 v[72:75], v4 offset:2048
    ds_read_b128 v[76:79], v4 offset:2064
    ds_read_b128 v[80:83], v4 offset:4096
    ds_read_b128 v[84:87], v4 offset:4112
    ds_read_b128 v[88:91], v4 offset:6144
    ds_read_b128 v[92:95], v4 offset:6160
    s_waitcnt lgkmcnt(0)
    v_pk_add_f32 v[64:65], v[64:65], v[72:73]
    v_pk_add_f32 v[80:81], v[80:81], v[88:89]
    v_pk_add_f32 v[64:65], v[64:65], v[80:81]
    v_cvt_pk_bf16_f32 v32, v64, v65
    v_pk_add_f32 v[66:67], v[66:67], v[74:75]
    v_pk_add_f32 v[82:83], v[82:83], v[90:91]
    v_pk_add_f32 v[66:67], v[66:67], v[82:83]
    v_cvt_pk_bf16_f32 v33, v66, v67
    v_pk_add_f32 v[68:69], v[68:69], v[76:77]
    v_pk_add_f32 v[84:85], v[84:85], v[92:93]
    v_pk_add_f32 v[68:69], v[68:69], v[84:85]
    v_cvt_pk_bf16_f32 v34, v68, v69
    v_pk_add_f32 v[70:71], v[70:71], v[78:79]
    v_pk_add_f32 v[86:87], v[86:87], v[94:95]
    v_pk_add_f32 v[70:71], v[70:71], v[86:87]
    v_cvt_pk_bf16_f32 v35, v70, v71
    ds_write_b128 v5, v[32:35]
    s_waitcnt lgkmcnt(0)
    ds_read_b128 v[64:67], v6 offset:0
    ds_read_b128 v[68:71], v6 offset:64
    ds_read_b128 v[72:75], v6 offset:128
    ds_read_b128 v[76:79], v6 offset:192
    ds_read_b128 v[80:83], v6 offset:256
    ds_read_b128 v[84:87], v6 offset:320
    ds_read_b128 v[88:91], v6 offset:384
    ds_read_b128 v[92:95], v6 offset:448
    ds_read_b128 v[96:99], v6 offset:512
    ds_read_b128 v[100:103], v6 offset:576
    ds_read_b128 v[104:107], v6 offset:640
    ds_read_b128 v[108:111], v6 offset:704
    ds_read_b128 v[112:115], v6 offset:768
    ds_read_b128 v[116:119], v6 offset:832
    ds_read_b128 v[120:123], v6 offset:896
    ds_read_b128 v[124:127], v6 offset:960
    s_waitcnt lgkmcnt(15)
    v_mfma_f32_16x16x32_bf16 v[28:31], v[128:131], v[64:67], 0
    v_mfma_f32_16x16x32_bf16 v[32:35], v[132:135], v[64:67], 0
    s_waitcnt lgkmcnt(14)
    v_mfma_f32_16x16x32_bf16 v[28:31], v[136:139], v[68:71], v[28:31]
    v_mfma_f32_16x16x32_bf16 v[32:35], v[140:143], v[68:71], v[32:35]
    s_waitcnt lgkmcnt(13)
    v_mfma_f32_16x16x32_bf16 v[28:31], v[144:147], v[72:75], v[28:31]
    v_mfma_f32_16x16x32_bf16 v[32:35], v[148:151], v[72:75], v[32:35]
    s_waitcnt lgkmcnt(12)
    v_mfma_f32_16x16x32_bf16 v[28:31], v[152:155], v[76:79], v[28:31]
    v_mfma_f32_16x16x32_bf16 v[32:35], v[156:159], v[76:79], v[32:35]
    s_waitcnt lgkmcnt(11)
    v_mfma_f32_16x16x32_bf16 v[28:31], v[160:163], v[80:83], v[28:31]
    v_mfma_f32_16x16x32_bf16 v[32:35], v[164:167], v[80:83], v[32:35]
    s_waitcnt lgkmcnt(10)
    v_mfma_f32_16x16x32_bf16 v[28:31], v[168:171], v[84:87], v[28:31]
    v_mfma_f32_16x16x32_bf16 v[32:35], v[172:175], v[84:87], v[32:35]
    s_waitcnt lgkmcnt(9)
    v_mfma_f32_16x16x32_bf16 v[28:31], v[176:179], v[88:91], v[28:31]
    v_mfma_f32_16x16x32_bf16 v[32:35], v[180:183], v[88:91], v[32:35]
    s_waitcnt lgkmcnt(8)
    v_mfma_f32_16x16x32_bf16 v[28:31], v[184:187], v[92:95], v[28:31]
    v_mfma_f32_16x16x32_bf16 v[32:35], v[188:191], v[92:95], v[32:35]
    s_waitcnt lgkmcnt(7)
    v_mfma_f32_16x16x32_bf16 v[28:31], v[192:195], v[96:99], v[28:31]
    v_mfma_f32_16x16x32_bf16 v[32:35], v[196:199], v[96:99], v[32:35]
    s_waitcnt lgkmcnt(6)
    v_mfma_f32_16x16x32_bf16 v[28:31], v[200:203], v[100:103], v[28:31]
    v_mfma_f32_16x16x32_bf16 v[32:35], v[204:207], v[100:103], v[32:35]
    s_waitcnt lgkmcnt(5)
    v_mfma_f32_16x16x32_bf16 v[28:31], v[208:211], v[104:107], v[28:31]
    v_mfma_f32_16x16x32_bf16 v[32:35], v[212:215], v[104:107], v[32:35]
    s_waitcnt lgkmcnt(4)
    v_mfma_f32_16x16x32_bf16 v[28:31], v[216:219], v[108:111], v[28:31]
    v_mfma_f32_16x16x32_bf16 v[32:35], v[220:223], v[108:111], v[32:35]
    s_waitcnt lgkmcnt(3)
    v_mfma_f32_16x16x32_bf16 v[28:31], v[224:227], v[112:115], v[28:31]
    v_mfma_f32_16x16x32_bf16 v[32:35], v[228:231], v[112:115], v[32:35]
    s_waitcnt lgkmcnt(2)
    v_mfma_f32_16x16x32_bf16 v[28:31], v[232:235], v[116:119], v[28:31]
    v_mfma_f32_16x16x32_bf16 v[32:35], v[236:239], v[116:119], v[32:35]
    s_waitcnt lgkmcnt(1)
    v_mfma_f32_16x16x32_bf16 v[28:31], v[240:243], v[120:123], v[28:31]
    v_mfma_f32_16x16x32_bf16 v[32:35], v[244:247], v[120:123], v[32:35]
    s_waitcnt lgkmcnt(0)
    v_mfma_f32_16x16x32_bf16 v[28:31], v[248:251], v[124:127], v[28:31]
    v_mfma_f32_16x16x32_bf16 v[32:35], v[252:255], v[124:127], v[32:35]
    s_nop 7
    v_cvt_pk_bf16_f32 v36, v28, v29
    v_cvt_pk_bf16_f32 v37, v30, v31
    v_cvt_pk_bf16_f32 v40, v32, v33
    v_cvt_pk_bf16_f32 v41, v34, v35
    v_cndmask_b32 v36, v36, v40, s[52:53]
    v_cndmask_b32 v37, v37, v41, s[52:53]
    s_and_saveexec_b64 s[48:49], vcc
    global_store_dwordx4 v14, v[36:39], s[32:33] sc1
    s_mov_b64 exec, s[48:49]
    s_branch L_fin
L_T5_c:
    v_lshlrev_b32 v26, 4, v1
    v_add_u32 v26, 162048, v26
    s_lshl_b32 s42, s3, 8
    v_add_u32 v27, s42, v26
    s_waitcnt lgkmcnt(0)
    s_add_u32 s36, s38, 1
    s_not_b32 s37, s36
    s_and_b32 s55, s51, 1
    s_lshl_b32 s42, s55, 13
    s_add_u32 s42, s42, 8388608
    v_lshl_add_u32 v4, v3, 4, s42
    v_add_u32 v5, 4096, v4
    v_mov_b32 v10, v4
    v_mov_b32 v11, v5
    v_add_u32 v12, 16384, v4
    v_add_u32 v13, 16384, v5
    v_add_u32 v14, 32768, v4
    v_add_u32 v15, 32768, v5
    v_add_u32 v16, 49152, v4
    v_add_u32 v17, 49152, v5
    v_lshrrev_b32 v20, 3, v3
    v_lshlrev_b32 v20, 6, v20
    v_and_b32 v22, 3, v3
    v_lshl_add_u32 v20, v22, 4, v20
    v_bfe_u32 v22, v3, 2, 1
    v_lshl_add_u32 v20, v22, 3, v20
    v_add_u32 v20, 131072, v20
    s_lshr_b32 s42, s3, 1
    s_lshl_b32 s42, s42, 11
    v_and_b32 v8, 3, v0
    v_mul_u32_u24 v8, 4160, v8
    v_lshlrev_b32 v9, 4, v2
    s_add_u32 s47, s42, 131072
    v_add3_u32 v8, v8, v9, s47
    s_and_b32 s46, s3, 1
    v_lshrrev_b32 v18, 2, v1
    v_lshl_add_u32 v18, v2, 2, v18
    v_lshlrev_b32 v9, 6, v18
    v_bfe_u32 v18, v1, 1, 1
    v_and_b32 v19, 1, v2
    v_lshlrev_b32 v19, 1, v19
    v_xor_b32 v18, v18, v19
    s_lshl_b32 s47, s46, 1
    v_xor_b32 v18, s47, v18
    v_lshl_add_u32 v9, v18, 4, v9
    v_and_b32 v18, 1, v1
    v_lshl_add_u32 v9, v18, 3, v9
    s_lshr_b32 s42, s3, 1
    s_lshl_b32 s42, s42, 16
    v_add_u32 v9, s42, v9
    s_mul_i32 s42, s55, 640
    s_lshr_b32 s43, s51, 1
    s_lshl_b32 s43, s43, 5
    s_add_u32 s42, s42, s43
    s_lshl_b32 s43, s46, 4
    s_add_u32 s42, s42, s43
    s_lshl_b32 s42, s42, 4
    s_add_u32 s42, s42, 8519680
    v_lshl_add_u32 v21, v1, 4, s42
L_lw_49:
    s_sleep 1
    ds_read_b32 v63, v61 offset:40
    s_waitcnt lgkmcnt(0)
    v_readfirstlane_b32 s59, v63
    s_cmp_lt_u32 s59, 4
    s_cbranch_scc1 L_lw_49
    ds_read_b64_tr_b16 v[128:129], v9 offset:0
    ds_read_b64_tr_b16 v[130:131], v9 offset:1024
    ds_read_b64_tr_b16 v[132:133], v9 offset:2048
    ds_read_b64_tr_b16 v[134:135], v9 offset:3072
    ds_read_b64_tr_b16 v[136:137], v9 offset:4096
    ds_read_b64_tr_b16 v[138:139], v9 offset:5120
    ds_read_b64_tr_b16 v[140:141], v9 offset:6144
    ds_read_b64_tr_b16 v[142:143], v9 offset:7168
    ds_read_b64_tr_b16 v[144:145], v9 offset:8192
    ds_read_b64_tr_b16 v[146:147], v9 offset:9216
    ds_read_b64_tr_b16 v[148:149], v9 offset:10240
    ds_read_b64_tr_b16 v[150:151], v9 offset:11264
    ds_read_b64_tr_b16 v[152:153], v9 offset:12288
    ds_read_b64_tr_b16 v[154:155], v9 offset:13312
    ds_read_b64_tr_b16 v[156:157], v9 offset:14336
    ds_read_b64_tr_b16 v[158:159], v9 offset:15360
    ds_read_b64_tr_b16 v[160:161], v9 offset:16384
    ds_read_b64_tr_b16 v[162:163], v9 offset:17408
    ds_read_b64_tr_b16 v[164:165], v9 offset:18432
    ds_read_b64_tr_b16 v[166:167], v9 offset:19456
    ds_read_b64_tr_b16 v[168:169], v9 offset:20480
    ds_read_b64_tr_b16 v[170:171], v9 offset:21504
    ds_read_b64_tr_b16 v[172:173], v9 offset:22528
    ds_read_b64_tr_b16 v[174:175], v9 offset:23552
    ds_read_b64_tr_b16 v[176:177], v9 offset:24576
    ds_read_b64_tr_b16 v[178:179], v9 offset:25600
    ds_read_b64_tr_b16 v[180:181], v9 offset:26624
    ds_read_b64_tr_b16 v[182:183], v9 offset:27648
    ds_read_b64_tr_b16 v[184:185], v9 offset:28672
    ds_read_b64_tr_b16 v[186:187], v9 offset:29696
    ds_read_b64_tr_b16 v[188:189], v9 offset:30720
    ds_read_b64_tr_b16 v[190:191], v9 offset:31744
    ds_read_b64_tr_b16 v[192:193], v9 offset:32768
    ds_read_b64_tr_b16 v[194:195], v9 offset:33792
    ds_read_b64_tr_b16 v[196:197], v9 offset:34816
    ds_read_b64_tr_b16 v[198:199], v9 offset:35840
    ds_read_b64_tr_b16 v[200:201], v9 offset:36864
    ds_read_b64_tr_b16 v[202:203], v9 offset:37888
    ds_read_b64_tr_b16 v[204:205], v9 offset:38912
    ds_read_b64_tr_b16 v[206:207], v9 offset:39936
    ds_read_b64_tr_b16 v[208:209], v9 offset:40960
    ds_read_b64_tr_b16 v[210:211], v9 offset:41984
    ds_read_b64_tr_b16 v[212:213], v9 offset:43008
    ds_read_b64_tr_b16 v[214:215], v9 offset:44032
    ds_read_b64_tr_b16 v[216:217], v9 offset:45056
    ds_read_b64_tr_b16 v[218:219], v9 offset:46080
    ds_read_b64_tr_b16 v[220:221], v9 offset:47104
    ds_read_b64_tr_b16 v[222:223], v9 offset:48128
    ds_read_b64_tr_b16 v[224:225], v9 offset:49152
    ds_read_b64_tr_b16 v[226:227], v9 offset:50176
    ds_read_b64_tr_b16 v[228:229], v9 offset:51200
    ds_read_b64_tr_b16 v[230:231], v9 offset:52224
    ds_read_b64_tr_b16 v[232:233], v9 offset:53248
    ds_read_b64_tr_b16 v[234:235], v9 offset:54272
    ds_read_b64_tr_b16 v[236:237], v9 offset:55296
    ds_read_b64_tr_b16 v[238:239], v9 offset:56320
    ds_read_b64_tr_b16 v[240:241], v9 offset:57344
    ds_read_b64_tr_b16 v[242:243], v9 offset:58368
    ds_read_b64_tr_b16 v[244:245], v9 offset:59392
    ds_read_b64_tr_b16 v[246:247], v9 offset:60416
    ds_read_b64_tr_b16 v[248:249], v9 offset:61440
    ds_read_b64_tr_b16 v[250:251], v9 offset:62464
    ds_read_b64_tr_b16 v[252:253], v9 offset:63488
    ds_read_b64_tr_b16 v[254:255], v9 offset:64512
    s_waitcnt lgkmcnt(0)
    s_mov_b32 s50, 0
L_poll_50:
    global_load_dwordx4 v[64:67], v10, s[32:33] sc1
    global_load_dwordx4 v[68:71], v11, s[32:33] sc1
    global_load_dwordx4 v[72:75], v12, s[32:33] sc1
    global_load_dwordx4 v[76:79], v13, s[32:33] sc1
    global_load_dwordx4 v[80:83], v14, s[32:33] sc1
    global_load_dwordx4 v[84:87], v15, s[32:33] sc1
    global_load_dwordx4 v[88:91], v16, s[32:33] sc1
    global_load_dwordx4 v[92:95], v17, s[32:33] sc1
    s_add_u32 s50, s50, 1
    s_waitcnt vmcnt(0)
    v_xor_b32 v58, s36, v66
    v_xor_b32 v59, s37, v67
    v_xor_b32 v57, s36, v70
    v_xor_b32 v56, s37, v71
    v_or3_b32 v58, v58, v57, v56
    v_xor_b32 v57, s36, v74
    v_xor_b32 v56, s37, v75
    v_or3_b32 v58, v58, v57, v56
    v_xor_b32 v57, s36, v78
    v_xor_b32 v56, s37, v79
    v_or3_b32 v58, v58, v57, v56
    v_xor_b32 v57, s36, v82
    v_xor_b32 v56, s37, v83
    v_or3_b32 v58, v58, v57, v56
    v_xor_b32 v57, s36, v86
    v_xor_b32 v56, s37, v87
    v_or3_b32 v58, v58, v57, v56
    v_xor_b32 v57, s36, v90
    v_xor_b32 v56, s37, v91
    v_or3_b32 v58, v58, v57, v56
    v_xor_b32 v57, s36, v94
    v_xor_b32 v56, s37, v95
    v_or3_b32 v58, v58, v57, v56
    v_or_b32 v58, v58, v59
    v_cmp_ne_u32 vcc, 0, v58
    s_cmp_ge_u32 s50, 262144
    s_cbranch_scc1 L_polld_51
    s_cbranch_vccnz L_poll_50
L_polld_51:
    ds_write_b64 v20, v[64:65] offset:0
    ds_write_b64 v20, v[68:69] offset:2048
    ds_write_b64 v20, v[72:73] offset:4160
    ds_write_b64 v20, v[76:77] offset:6208
    ds_write_b64 v20, v[80:81] offset:8320
    ds_write_b64 v20, v[84:85] offset:10368
    ds_write_b64 v20, v[88:89] offset:12480
    ds_write_b64 v20, v[92:93] offset:14528
    s_mov_b64 s[100:101], exec
    s_mov_b64 exec, 1
    ds_add_u32 v61, v62 offset:44
    s_mov_b64 exec, s[100:101]
L_lw_52:
    ds_read_b32 v63, v61 offset:44
    s_waitcnt lgkmcnt(0)
    v_readfirstlane_b32 s59, v63
    s_cmp_lt_u32 s59, 4
    s_cbranch_scc1 L_lw_52
    s_waitcnt vmcnt(0)
    ds_read_b128 v[64:67], v8 offset:0
    ds_read_b128 v[68:71], v8 offset:64
    ds_read_b128 v[72:75], v8 offset:128
    ds_read_b128 v[76:79], v8 offset:192
    ds_read_b128 v[80:83], v8 offset:256
    ds_read_b128 v[84:87], v8 offset:320
    ds_read_b128 v[88:91], v8 offset:384
    ds_read_b128 v[92:95], v8 offset:448
    ds_read_b128 v[96:99], v8 offset:512
    ds_read_b128 v[100:103], v8 offset:576
    ds_read_b128 v[104:107], v8 offset:640
    ds_read_b128 v[108:111], v8 offset:704
    ds_read_b128 v[112:115], v8 offset:768
    ds_read_b128 v[116:119], v8 offset:832
    ds_read_b128 v[120:123], v8 offset:896
    ds_read_b128 v[124:127], v8 offset:960
    s_waitcnt lgkmcnt(15)
    v_mfma_f32_16x16x32_bf16 v[28:31], v[64:67], v[128:131], 0
    s_waitcnt lgkmcnt(14)
    v_mfma_f32_16x16x32_bf16 v[28:31], v[68:71], v[132:135], v[28:31]
    s_waitcnt lgkmcnt(13)
    v_mfma_f32_16x16x32_bf16 v[28:31], v[72:75], v[136:139], v[28:31]
    s_waitcnt lgkmcnt(12)
    v_mfma_f32_16x16x32_bf16 v[28:31], v[76:79], v[140:143], v[28:31]
    s_waitcnt lgkmcnt(11)
    v_mfma_f32_16x16x32_bf16 v[28:31], v[80:83], v[144:147], v[28:31]
    s_waitcnt lgkmcnt(10)
    v_mfma_f32_16x16x32_bf16 v[28:31], v[84:87], v[148:151], v[28:31]
    s_waitcnt lgkmcnt(9)
    v_mfma_f32_16x16x32_bf16 v[28:31], v[88:91], v[152:155], v[28:31]
    s_waitcnt lgkmcnt(8)
    v_mfma_f32_16x16x32_bf16 v[28:31], v[92:95], v[156:159], v[28:31]
    s_waitcnt lgkmcnt(7)
    v_mfma_f32_16x16x32_bf16 v[28:31], v[96:99], v[160:163], v[28:31]
    s_waitcnt lgkmcnt(6)
    v_mfma_f32_16x16x32_bf16 v[28:31], v[100:103], v[164:167], v[28:31]
    s_waitcnt lgkmcnt(5)
    v_mfma_f32_16x16x32_bf16 v[28:31], v[104:107], v[168:171], v[28:31]
    s_waitcnt lgkmcnt(4)
    v_mfma_f32_16x16x32_bf16 v[28:31], v[108:111], v[172:175], v[28:31]
    s_waitcnt lgkmcnt(3)
    v_mfma_f32_16x16x32_bf16 v[28:31], v[112:115], v[176:179], v[28:31]
    s_waitcnt lgkmcnt(2)
    v_mfma_f32_16x16x32_bf16 v[28:31], v[116:119], v[180:183], v[28:31]
    s_waitcnt lgkmcnt(1)
    v_mfma_f32_16x16x32_bf16 v[28:31], v[120:123], v[184:187], v[28:31]
    s_waitcnt lgkmcnt(0)
    v_mfma_f32_16x16x32_bf16 v[28:31], v[124:127], v[188:191], v[28:31]
    ds_read_b128 v[64:67], v8 offset:1024
    ds_read_b128 v[68:71], v8 offset:1088
    ds_read_b128 v[72:75], v8 offset:1152
    ds_read_b128 v[76:79], v8 offset:1216
    ds_read_b128 v[80:83], v8 offset:1280
    ds_read_b128 v[84:87], v8 offset:1344
    ds_read_b128 v[88:91], v8 offset:1408
    ds_read_b128 v[92:95], v8 offset:1472
    ds_read_b128 v[96:99], v8 offset:1536
    ds_read_b128 v[100:103], v8 offset:1600
    ds_read_b128 v[104:107], v8 offset:1664
    ds_read_b128 v[108:111], v8 offset:1728
    ds_read_b128 v[112:115], v8 offset:1792
    ds_read_b128 v[116:119], v8 offset:1856
    ds_read_b128 v[120:123], v8 offset:1920
    ds_read_b128 v[124:127], v8 offset:1984
    s_waitcnt lgkmcnt(15)
    v_mfma_f32_16x16x32_bf16 v[28:31], v[64:67], v[192:195], v[28:31]
    s_waitcnt lgkmcnt(14)
    v_mfma_f32_16x16x32_bf16 v[28:31], v[68:71], v[196:199], v[28:31]
    s_waitcnt lgkmcnt(13)
    v_mfma_f32_16x16x32_bf16 v[28:31], v[72:75], v[200:203], v[28:31]
    s_waitcnt lgkmcnt(12)
    v_mfma_f32_16x16x32_bf16 v[28:31], v[76:79], v[204:207], v[28:31]
    s_waitcnt lgkmcnt(11)
    v_mfma_f32_16x16x32_bf16 v[28:31], v[80:83], v[208:211], v[28:31]
    s_waitcnt lgkmcnt(10)
    v_mfma_f32_16x16x32_bf16 v[28:31], v[84:87], v[212:215], v[28:31]
    s_waitcnt lgkmcnt(9)
    v_mfma_f32_16x16x32_bf16 v[28:31], v[88:91], v[216:219], v[28:31]
    s_waitcnt lgkmcnt(8)
    v_mfma_f32_16x16x32_bf16 v[28:31], v[92:95], v[220:223], v[28:31]
    s_waitcnt lgkmcnt(7)
    v_mfma_f32_16x16x32_bf16 v[28:31], v[96:99], v[224:227], v[28:31]
    s_waitcnt lgkmcnt(6)
    v_mfma_f32_16x16x32_bf16 v[28:31], v[100:103], v[228:231], v[28:31]
    s_waitcnt lgkmcnt(5)
    v_mfma_f32_16x16x32_bf16 v[28:31], v[104:107], v[232:235], v[28:31]
    s_waitcnt lgkmcnt(4)
    v_mfma_f32_16x16x32_bf16 v[28:31], v[108:111], v[236:239], v[28:31]
    s_waitcnt lgkmcnt(3)
    v_mfma_f32_16x16x32_bf16 v[28:31], v[112:115], v[240:243], v[28:31]
    s_waitcnt lgkmcnt(2)
    v_mfma_f32_16x16x32_bf16 v[28:31], v[116:119], v[244:247], v[28:31]
    s_waitcnt lgkmcnt(1)
    v_mfma_f32_16x16x32_bf16 v[28:31], v[120:123], v[248:251], v[28:31]
    s_waitcnt lgkmcnt(0)
    v_mfma_f32_16x16x32_bf16 v[28:31], v[124:127], v[252:255], v[28:31]
    s_cmp_lt_u32 s3, 2
    s_cbranch_scc1 L_pr_53
    s_nop 7
    s_mov_b64 s[48:49], exec
    s_mov_b64 exec, 0xffff
    ds_write_b128 v27, v[28:31]
    s_mov_b64 exec, s[48:49]
    s_mov_b64 s[100:101], exec
    s_mov_b64 exec, 1
    ds_add_u32 v61, v62 offset:48
    s_mov_b64 exec, s[100:101]
    s_branch L_fin
L_pr_53:
L_lw_54:
    ds_read_b32 v63, v61 offset:48
    s_waitcnt lgkmcnt(0)
    v_readfirstlane_b32 s59, v63
    s_cmp_lt_u32 s59, 2
    s_cbranch_scc1 L_lw_54
    ds_read_b128 v[64:67], v27 offset:512
    s_waitcnt lgkmcnt(0)
    v_pk_add_f32 v[28:29], v[28:29], v[64:65]
    v_pk_add_f32 v[30:31], v[30:31], v[66:67]
    s_mov_b64 s[48:49], exec
    s_mov_b64 exec, 0xffff
    v_cvt_pk_bf16_f32 v64, v28, v29
    v_cvt_pk_bf16_f32 v65, v30, v31
    v_mov_b32 v66, s36
    v_mov_b32 v67, s37
    global_store_dwordx4 v21, v[64:67], s[32:33] sc1
    s_mov_b64 exec, s[48:49]
    s_branch L_fin
L_T7_c:
    s_cmp_ge_u32 s54, 20
    s_cbranch_scc1 L_fin
    v_lshlrev_b32 v26, 4, v1
    v_add_u32 v26, 162048, v26
    s_lshl_b32 s42, s3, 8
    v_add_u32 v27, s42, v26
    s_waitcnt lgkmcnt(0)
    s_add_u32 s36, s38, 1
    s_not_b32 s37, s36
    s_lshl_b32 s42, s54, 5
    s_and_b32 s46, s3, 1
    s_lshl_b32 s43, s46, 4
    s_add_u32 s42, s42, s43
    v_add_u32 v5, s42, v1
    v_lshlrev_b32 v19, 1, v5
    global_load_ushort v96, v19, s[4:5] offset:0
    global_load_ushort v97, v19, s[4:5] offset:1280
    global_load_ushort v98, v19, s[4:5] offset:2560
    global_load_ushort v99, v19, s[4:5] offset:3840
    v_lshlrev_b32 v4, 4, v5
    v_add_u32 v11, 24576, v4
    v_add_u32 v12, 55296, v4
    v_add_u32 v13, 8519680, v4
    v_add_u32 v14, 8529920, v4
    v_add_u32 v5, 256, v3
    v_min_u32 v5, 431, v5
    v_lshrrev_b32 v4, 2, v3
    v_lshlrev_b32 v4, 8, v4
    v_and_b32 v6, 3, v3
    v_lshl_add_u32 v4, v6, 4, v4
    v_add_u32 v4, 8585216, v4
    v_lshrrev_b32 v6, 2, v5
    v_lshlrev_b32 v6, 8, v6
    v_and_b32 v7, 3, v5
    v_lshl_add_u32 v6, v7, 4, v6
    v_add_u32 v6, 8585216, v6
    v_lshrrev_b32 v20, 3, v3
    v_lshlrev_b32 v20, 6, v20
    v_and_b32 v22, 3, v3
    v_lshl_add_u32 v20, v22, 4, v20
    v_bfe_u32 v22, v3, 2, 1
    v_lshl_add_u32 v20, v22, 3, v20
    v_add_u32 v20, 131072, v20
    v_lshrrev_b32 v21, 3, v5
    v_lshlrev_b32 v21, 6, v21
    v_and_b32 v22, 3, v5
    v_lshl_add_u32 v21, v22, 4, v21
    v_bfe_u32 v22, v5, 2, 1
    v_lshl_add_u32 v21, v22, 3, v21
    v_add_u32 v21, 131072, v21
    s_lshr_b32 s42, s3, 1
    s_mul_i32 s42, s42, 1728
    v_and_b32 v8, 3, v0
    v_mul_u32_u24 v8, 3648, v8
    v_lshlrev_b32 v9, 4, v2
    s_add_u32 s47, s42, 131072
    v_add3_u32 v8, v8, v9, s47
    v_lshrrev_b32 v16, 2, v1
    v_lshl_add_u32 v16, v2, 2, v16
    v_lshlrev_b32 v9, 6, v16
    v_bfe_u32 v16, v1, 1, 1
    v_and_b32 v17, 1, v2
    v_lshlrev_b32 v17, 1, v17
    v_xor_b32 v16, v16, v17
    s_lshl_b32 s47, s46, 1
    v_xor_b32 v16, s47, v16
    v_lshl_add_u32 v9, v16, 4, v9
    v_and_b32 v16, 1, v1
    v_lshl_add_u32 v9, v16, 3, v9
    s_lshr_b32 s42, s3, 1
    s_mul_i32 s42, s42, 55296
    v_add_u32 v9, s42, v9
L_lw_55:
    s_sleep 1
    ds_read_b32 v63, v61 offset:40
    s_waitcnt lgkmcnt(0)
    v_readfirstlane_b32 s59, v63
    s_cmp_lt_u32 s59, 4
    s_cbranch_scc1 L_lw_55
    ds_read_b64_tr_b16 v[128:129], v9 offset:0
    ds_read_b64_tr_b16 v[130:131], v9 offset:1024
    ds_read_b64_tr_b16 v[132:133], v9 offset:2048
    ds_read_b64_tr_b16 v[134:135], v9 offset:3072
    ds_read_b64_tr_b16 v[136:137], v9 offset:4096
    ds_read_b64_tr_b16 v[138:139], v9 offset:5120
    ds_read_b64_tr_b16 v[140:141], v9 offset:6144
    ds_read_b64_tr_b16 v[142:143], v9 offset:7168
    ds_read_b64_tr_b16 v[144:145], v9 offset:8192
    ds_read_b64_tr_b16 v[146:147], v9 offset:9216
    ds_read_b64_tr_b16 v[148:149], v9 offset:10240
    ds_read_b64_tr_b16 v[150:151], v9 offset:11264
    ds_read_b64_tr_b16 v[152:153], v9 offset:12288
    ds_read_b64_tr_b16 v[154:155], v9 offset:13312
    ds_read_b64_tr_b16 v[156:157], v9 offset:14336
    ds_read_b64_tr_b16 v[158:159], v9 offset:15360
    ds_read_b64_tr_b16 v[160:161], v9 offset:16384
    ds_read_b64_tr_b16 v[162:163], v9 offset:17408
    ds_read_b64_tr_b16 v[164:165], v9 offset:18432
    ds_read_b64_tr_b16 v[166:167], v9 offset:19456
    ds_read_b64_tr_b16 v[168:169], v9 offset:20480
    ds_read_b64_tr_b16 v[170:171], v9 offset:21504
    ds_read_b64_tr_b16 v[172:173], v9 offset:22528
    ds_read_b64_tr_b16 v[174:175], v9 offset:23552
    ds_read_b64_tr_b16 v[176:177], v9 offset:24576
    ds_read_b64_tr_b16 v[178:179], v9 offset:25600
    ds_read_b64_tr_b16 v[180:181], v9 offset:26624
    ds_read_b64_tr_b16 v[182:183], v9 offset:27648
    ds_read_b64_tr_b16 v[184:185], v9 offset:28672
    ds_read_b64_tr_b16 v[186:187], v9 offset:29696
    ds_read_b64_tr_b16 v[188:189], v9 offset:30720
    ds_read_b64_tr_b16 v[190:191], v9 offset:31744
    ds_read_b64_tr_b16 v[192:193], v9 offset:32768
    ds_read_b64_tr_b16 v[194:195], v9 offset:33792
    ds_read_b64_tr_b16 v[196:197], v9 offset:34816
    ds_read_b64_tr_b16 v[198:199], v9 offset:35840
    ds_read_b64_tr_b16 v[200:201], v9 offset:36864
    ds_read_b64_tr_b16 v[202:203], v9 offset:37888
    ds_read_b64_tr_b16 v[204:205], v9 offset:38912
    ds_read_b64_tr_b16 v[206:207], v9 offset:39936
    ds_read_b64_tr_b16 v[208:209], v9 offset:40960
    ds_read_b64_tr_b16 v[210:211], v9 offset:41984
    ds_read_b64_tr_b16 v[212:213], v9 offset:43008
    ds_read_b64_tr_b16 v[214:215], v9 offset:44032
    ds_read_b64_tr_b16 v[216:217], v9 offset:45056
    ds_read_b64_tr_b16 v[218:219], v9 offset:46080
    ds_read_b64_tr_b16 v[220:221], v9 offset:47104
    ds_read_b64_tr_b16 v[222:223], v9 offset:48128
    ds_read_b64_tr_b16 v[224:225], v9 offset:49152
    ds_read_b64_tr_b16 v[226:227], v9 offset:50176
    ds_read_b64_tr_b16 v[228:229], v9 offset:51200
    ds_read_b64_tr_b16 v[230:231], v9 offset:52224
    ds_read_b64_tr_b16 v[232:233], v9 offset:53248
    ds_read_b64_tr_b16 v[234:235], v9 offset:54272
    s_waitcnt lgkmcnt(0)
    s_mov_b32 s50, 0
L_poll_56:
    global_load_dwordx4 v[108:111], v11, s[32:33] sc1
    global_load_dwordx4 v[240:243], v12, s[32:33] sc1
    global_load_dwordx4 v[116:119], v13, s[32:33] sc1
    global_load_dwordx4 v[120:123], v14, s[32:33] sc1
    s_add_u32 s50, s50, 1
    s_waitcnt vmcnt(0)
    v_xor_b32 v58, s36, v110
    v_xor_b32 v59, s37, v111
    v_xor_b32 v57, s36, v242
    v_xor_b32 v56, s37, v243
    v_or3_b32 v58, v58, v57, v56
    v_xor_b32 v57, s36, v118
    v_xor_b32 v56, s37, v119
    v_or3_b32 v58, v58, v57, v56
    v_xor_b32 v57, s36, v122
    v_xor_b32 v56, s37, v123
    v_or3_b32 v58, v58, v57, v56
    v_or_b32 v58, v58, v59
    v_cmp_ne_u32 vcc, 0, v58
    s_cmp_ge_u32 s50, 262144
    s_cbranch_scc1 L_polld_57
    s_cbranch_vccnz L_poll_56
L_polld_57:
    v_lshlrev_b32 v90, 16, v116
    v_and_b32 v91, 0xffff0000, v116
    v_lshlrev_b32 v92, 16, v120
    v_and_b32 v93, 0xffff0000, v120
    v_lshlrev_b32 v94, 16, v108
    v_and_b32 v95, 0xffff0000, v108
    v_add_f32 v90, v90, v92
    v_add_f32 v91, v91, v93
    v_lshlrev_b32 v92, 16, v96
    v_lshlrev_b32 v93, 16, v97
    v_fma_f32 v90, v90, v94, v92
    v_fma_f32 v91, v91, v95, v93
    v_cvt_pk_bf16_f32 v90, v90, v91
    v_lshlrev_b32 v40, 16, v90
    v_and_b32 v41, 0xffff0000, v90
    v_lshlrev_b32 v44, 16, v240
    v_and_b32 v45, 0xffff0000, v240
    v_lshlrev_b32 v90, 16, v117
    v_and_b32 v91, 0xffff0000, v117
    v_lshlrev_b32 v92, 16, v121
    v_and_b32 v93, 0xffff0000, v121
    v_lshlrev_b32 v94, 16, v109
    v_and_b32 v95, 0xffff0000, v109
    v_add_f32 v90, v90, v92
    v_add_f32 v91, v91, v93
    v_lshlrev_b32 v92, 16, v98
    v_lshlrev_b32 v93, 16, v99
    v_fma_f32 v90, v90, v94, v92
    v_fma_f32 v91, v91, v95, v93
    v_cvt_pk_bf16_f32 v90, v90, v91
    v_lshlrev_b32 v42, 16, v90
    v_and_b32 v43, 0xffff0000, v90
    v_lshlrev_b32 v46, 16, v241
    v_and_b32 v47, 0xffff0000, v241
    s_mov_b32 s50, 0
L_poll_58:
    global_load_dwordx4 v[64:67], v4, s[32:33] offset:0 sc1
    global_load_dwordx4 v[68:71], v6, s[32:33] offset:0 sc1
    global_load_dwordx4 v[72:75], v4, s[32:33] offset:64 sc1
    global_load_dwordx4 v[76:79], v6, s[32:33] offset:64 sc1
    global_load_dwordx4 v[80:83], v4, s[32:33] offset:128 sc1
    global_load_dwordx4 v[84:87], v6, s[32:33] offset:128 sc1
    global_load_dwordx4 v[88:91], v4, s[32:33] offset:192 sc1
    global_load_dwordx4 v[92:95], v6, s[32:33] offset:192 sc1
    s_add_u32 s50, s50, 1
    s_waitcnt vmcnt(0)
    v_xor_b32 v58, s36, v66
    v_xor_b32 v59, s37, v67
    v_xor_b32 v57, s36, v70
    v_xor_b32 v56, s37, v71
    v_or3_b32 v58, v58, v57, v56
    v_xor_b32 v57, s36, v74
    v_xor_b32 v56, s37, v75
    v_or3_b32 v58, v58, v57, v56
    v_xor_b32 v57, s36, v78
    v_xor_b32 v56, s37, v79
    v_or3_b32 v58, v58, v57, v56
    v_xor_b32 v57, s36, v82
    v_xor_b32 v56, s37, v83
    v_or3_b32 v58, v58, v57, v56
    v_xor_b32 v57, s36, v86
    v_xor_b32 v56, s37, v87
    v_or3_b32 v58, v58, v57, v56
    v_xor_b32 v57, s36, v90
    v_xor_b32 v56, s37, v91
    v_or3_b32 v58, v58, v57, v56
    v_xor_b32 v57, s36, v94
    v_xor_b32 v56, s37, v95
    v_or3_b32 v58, v58, v57, v56
    v_or_b32 v58, v58, v59
    v_cmp_ne_u32 vcc, 0, v58
    s_cmp_ge_u32 s50, 262144
    s_cbranch_scc1 L_polld_59
    s_cbranch_vccnz L_poll_58
L_polld_59:
    ds_write_b64 v20, v[64:65] offset:0
    ds_write_b64 v21, v[68:69] offset:0
    ds_write_b64 v20, v[72:73] offset:3648
    ds_write_b64 v21, v[76:77] offset:3648
    ds_write_b64 v20, v[80:81] offset:7296
    ds_write_b64 v21, v[84:85] offset:7296
    ds_write_b64 v20, v[88:89] offset:10944
    ds_write_b64 v21, v[92:93] offset:10944
    s_mov_b64 s[100:101], exec
    s_mov_b64 exec, 1
    ds_add_u32 v61, v62 offset:44
    s_mov_b64 exec, s[100:101]
L_lw_60:
    ds_read_b32 v63, v61 offset:44
    s_waitcnt lgkmcnt(0)
    v_readfirstlane_b32 s59, v63
    s_cmp_lt_u32 s59, 4
    s_cbranch_scc1 L_lw_60
    s_waitcnt vmcnt(0)
    ds_read_b128 v[64:67], v8 offset:0
    ds_read_b128 v[68:71], v8 offset:64
    ds_read_b128 v[72:75], v8 offset:128
    ds_read_b128 v[76:79], v8 offset:192
    ds_read_b128 v[80:83], v8 offset:256
    ds_read_b128 v[84:87], v8 offset:320
    ds_read_b128 v[88:91], v8 offset:384
    ds_read_b128 v[92:95], v8 offset:448
    ds_read_b128 v[96:99], v8 offset:512
    ds_read_b128 v[100:103], v8 offset:576
    ds_read_b128 v[104:107], v8 offset:640
    ds_read_b128 v[108:111], v8 offset:704
    ds_read_b128 v[112:115], v8 offset:768
    ds_read_b128 v[116:119], v8 offset:832
    s_waitcnt lgkmcnt(13)
    v_mfma_f32_16x16x32_bf16 v[28:31], v[64:67], v[128:131], 0
    s_waitcnt lgkmcnt(12)
    v_mfma_f32_16x16x32_bf16 v[28:31], v[68:71], v[132:135], v[28:31]
    s_waitcnt lgkmcnt(11)
    v_mfma_f32_16x16x32_bf16 v[28:31], v[72:75], v[136:139], v[28:31]
    s_waitcnt lgkmcnt(10)
    v_mfma_f32_16x16x32_bf16 v[28:31], v[76:79], v[140:143], v[28:31]
    s_waitcnt lgkmcnt(9)
    v_mfma_f32_16x16x32_bf16 v[28:31], v[80:83], v[144:147], v[28:31]
    s_waitcnt lgkmcnt(8)
    v_mfma_f32_16x16x32_bf16 v[28:31], v[84:87], v[148:151], v[28:31]
    s_waitcnt lgkmcnt(7)
    v_mfma_f32_16x16x32_bf16 v[28:31], v[88:91], v[152:155], v[28:31]
    s_waitcnt lgkmcnt(6)
    v_mfma_f32_16x16x32_bf16 v[28:31], v[92:95], v[156:159], v[28:31]
    s_waitcnt lgkmcnt(5)
    v_mfma_f32_16x16x32_bf16 v[28:31], v[96:99], v[160:163], v[28:31]
    s_waitcnt lgkmcnt(4)
    v_mfma_f32_16x16x32_bf16 v[28:31], v[100:103], v[164:167], v[28:31]
    s_waitcnt lgkmcnt(3)
    v_mfma_f32_16x16x32_bf16 v[28:31], v[104:107], v[168:171], v[28:31]
    s_waitcnt lgkmcnt(2)
    v_mfma_f32_16x16x32_bf16 v[28:31], v[108:111], v[172:175], v[28:31]
    s_waitcnt lgkmcnt(1)
    v_mfma_f32_16x16x32_bf16 v[28:31], v[112:115], v[176:179], v[28:31]
    s_waitcnt lgkmcnt(0)
    v_mfma_f32_16x16x32_bf16 v[28:31], v[116:119], v[180:183], v[28:31]
    ds_read_b128 v[64:67], v8 offset:896
    ds_read_b128 v[68:71], v8 offset:960
    ds_read_b128 v[72:75], v8 offset:1024
    ds_read_b128 v[76:79], v8 offset:1088
    ds_read_b128 v[80:83], v8 offset:1152
    ds_read_b128 v[84:87], v8 offset:1216
    ds_read_b128 v[88:91], v8 offset:1280
    ds_read_b128 v[92:95], v8 offset:1344
    ds_read_b128 v[96:99], v8 offset:1408
    ds_read_b128 v[100:103], v8 offset:1472
    ds_read_b128 v[104:107], v8 offset:1536
    ds_read_b128 v[108:111], v8 offset:1600
    ds_read_b128 v[112:115], v8 offset:1664
    s_waitcnt lgkmcnt(12)
    v_mfma_f32_16x16x32_bf16 v[28:31], v[64:67], v[184:187], v[28:31]
    s_waitcnt lgkmcnt(11)
    v_mfma_f32_16x16x32_bf16 v[28:31], v[68:71], v[188:191], v[28:31]
    s_waitcnt lgkmcnt(10)
    v_mfma_f32_16x16x32_bf16 v[28:31], v[72:75], v[192:195], v[28:31]
    s_waitcnt lgkmcnt(9)
    v_mfma_f32_16x16x32_bf16 v[28:31], v[76:79], v[196:199], v[28:31]
    s_waitcnt lgkmcnt(8)
    v_mfma_f32_16x16x32_bf16 v[28:31], v[80:83], v[200:203], v[28:31]
    s_waitcnt lgkmcnt(7)
    v_mfma_f32_16x16x32_bf16 v[28:31], v[84:87], v[204:207], v[28:31]
    s_waitcnt lgkmcnt(6)
    v_mfma_f32_16x16x32_bf16 v[28:31], v[88:91], v[208:211], v[28:31]
    s_waitcnt lgkmcnt(5)
    v_mfma_f32_16x16x32_bf16 v[28:31], v[92:95], v[212:215], v[28:31]
    s_waitcnt lgkmcnt(4)
    v_mfma_f32_16x16x32_bf16 v[28:31], v[96:99], v[216:219], v[28:31]
    s_waitcnt lgkmcnt(3)
    v_mfma_f32_16x16x32_bf16 v[28:31], v[100:103], v[220:223], v[28:31]
    s_waitcnt lgkmcnt(2)
    v_mfma_f32_16x16x32_bf16 v[28:31], v[104:107], v[224:227], v[28:31]
    s_waitcnt lgkmcnt(1)
    v_mfma_f32_16x16x32_bf16 v[28:31], v[108:111], v[228:231], v[28:31]
    s_waitcnt lgkmcnt(0)
    v_mfma_f32_16x16x32_bf16 v[28:31], v[112:115], v[232:235], v[28:31]
    s_cmp_lt_u32 s3, 2
    s_cbranch_scc1 L_pr_61
    s_nop 7
    s_mov_b64 s[48:49], exec
    s_mov_b64 exec, 0xffff
    ds_write_b128 v27, v[28:31]
    s_mov_b64 exec, s[48:49]
    s_mov_b64 s[100:101], exec
    s_mov_b64 exec, 1
    ds_add_u32 v61, v62 offset:48
    s_mov_b64 exec, s[100:101]
    s_branch L_fin
L_pr_61:
L_lw_62:
    ds_read_b32 v63, v61 offset:48
    s_waitcnt lgkmcnt(0)
    v_readfirstlane_b32 s59, v63
    s_cmp_lt_u32 s59, 2
    s_cbranch_scc1 L_lw_62
    ds_read_b128 v[64:67], v27 offset:512
    s_waitcnt lgkmcnt(0)
    v_pk_add_f32 v[28:29], v[28:29], v[64:65]
    v_pk_add_f32 v[30:31], v[30:31], v[66:67]
    s_mov_b64 s[48:49], exec
    s_mov_b64 exec, 0xffff
    v_pk_fma_f32 v[28:29], v[28:29], v[44:45], v[40:41]
    v_pk_fma_f32 v[30:31], v[30:31], v[46:47], v[42:43]
    v_cvt_pk_bf16_f32 v64, v28, v29
    v_cvt_pk_bf16_f32 v65, v30, v31
    global_store_short v19, v64, s[28:29]
    global_store_short_d16_hi v19, v64, s[28:29] offset:1280
    global_store_short v19, v65, s[28:29] offset:2560
    global_store_short_d16_hi v19, v65, s[28:29] offset:3840
    s_mov_b64 exec, s[48:49]
    s_cmp_lg_u32 s54, 0
    s_cbranch_scc1 L_p7f_63
    s_cmp_lg_u32 s3, 0
    s_cbranch_scc1 L_p7f_63
    v_mov_b32 v4, 0
    v_mov_b32 v5, s36
    s_mov_b64 s[48:49], exec
    s_mov_b64 exec, 1
    global_store_dword v4, v5, s[32:33] sc1
    s_mov_b64 exec, s[48:49]
L_p7f_63:
L_fin:
    s_endpgm
L_codeend:
L_end:
    s_endpgm
.section .rodata,"a"
.p2align 6
.amdhsa_kernel adaLN_cond__compressed_kv_cla__glu_gated_geglu__decode_kernel
  .amdhsa_next_free_vgpr 256
  .amdhsa_next_free_sgpr 102
  .amdhsa_accum_offset 256
  .amdhsa_group_segment_fixed_size 0
  .amdhsa_kernarg_size 120
  .amdhsa_user_sgpr_count 2
  .amdhsa_user_sgpr_kernarg_segment_ptr 1
  .amdhsa_system_sgpr_workgroup_id_x 1
.end_amdhsa_kernel
```
